```python
import torch

def _softmax(x, axis=-1):
    return torch.softmax(x, dim=axis)
def _gelu(x):
    return torch.nn.functional.gelu(x, approximate="tanh")
def _silu(x):
    return torch.nn.functional.silu(x)
def _sigmoid(x):
    return torch.sigmoid(x)
def _layernorm(x, axis=-1, eps=1e-5):
    m = x.mean(dim=axis, keepdim=True)
    v = x.var(dim=axis, keepdim=True, unbiased=False)
    return (x - m) / torch.sqrt(v + eps)
def _scatter_add(tgt, idx, src, axis=0):
    return tgt.clone().index_add_(axis, idx, src)
def _segment_sum(src, seg, n):
    out = torch.zeros((n,) + src.shape[1:], dtype=src.dtype)
    return out.index_add_(0, seg, src)
def _pad(x, pw):
    flat = tuple(v for pair in reversed(pw) for v in pair)
    return torch.nn.functional.pad(x, flat)

kernel_name = 'standalone__mpnn_edge_mlp__graph'

def setup_inputs():

    _w = (lambda a: (lambda t: t.to(torch.bfloat16) if t.is_floating_point() else t)(torch.as_tensor(a)))
    N, deg, D, De = 12500, 32, 128, max(4, 1)
    E = N * deg
    return {
        "x": _w((lambda *s: torch.randn(*s, dtype=torch.bfloat16) * 0.05)(N, D)),
        "e_attr": _w((lambda *s: torch.randn(*s, dtype=torch.bfloat16) * 0.4)(E, De)),
        "src": _w((lambda lo, hi, *s: torch.randint(lo, hi, s))(0, N, E).to(torch.int64)),
        "dst": _w((lambda lo, hi, *s: torch.randint(lo, hi, s))(0, N, E).to(torch.int64)),
        "w_msg": _w((lambda *s: torch.randn(*s, dtype=torch.bfloat16) * 0.4)(2 * D + De, D)),
        "w_upd": _w((lambda *s: torch.randn(*s, dtype=torch.bfloat16) * 0.05)(2 * D, D)),
    }

def reference(x, e_attr, src, dst, w_msg, w_upd):
    N, D = x.shape
    m_in = torch.concatenate([x[src], x[dst], e_attr], axis=-1)
    msg = _silu(m_in @ w_msg)
    agg = _segment_sum(msg, dst, N)
    return _silu(torch.concatenate([x, agg], axis=-1) @ w_upd)
```

```asm
; @launch grid=(256,1,1) block=(1024,1,1) lds=163104
.amdgcn_target "amdgcn-amd-amdhsa--gfx950"
.text
.globl standalone__mpnn_edge_mlp__graph_kernel
.p2align 8
.type standalone__mpnn_edge_mlp__graph_kernel,@function
standalone__mpnn_edge_mlp__graph_kernel:
    s_load_dwordx16 s[4:19], s[0:1], 0
    s_load_dwordx2 s[20:21], s[0:1], 64
    s_cmpk_ge_u32 s2, 256
    s_cbranch_scc1 K_END
    v_lshrrev_b32 v1, 6, v0
    v_and_b32 v124, 63, v0
    v_readfirstlane_b32 s22, v1
    v_lshlrev_b32 v125, 4, v124
    v_mov_b32 v127, 0
    s_cmp_lg_u32 s22, 7
    s_cbranch_scc1 K_NOPF
    s_getpc_b64 s[96:97]
K_PC:
    s_lshr_b32 s3, s2, 3
    s_lshl_b32 s3, s3, 6
    s_add_u32 s96, s96, s3
    s_addc_u32 s97, s97, 0
    s_load_dword s53, s[96:97], 0
    s_load_dword s53, s[96:97], 4096
    s_load_dword s53, s[96:97], 6144
    s_load_dword s53, s[96:97], 10880
    s_load_dword s53, s[96:97], 2048
    s_load_dword s53, s[96:97], 8192
    s_load_dword s53, s[96:97], 10240
    s_barrier
K_NOPF:
    s_and_b32 s3, s2, 7
    s_lshl_b32 s3, s3, 5
    s_lshr_b32 s23, s2, 3
    s_add_u32 s23, s23, s3
    s_mul_i32 s94, s23, 12544
    s_sub_u32 s95, 3200000, s94
    s_min_u32 s95, s95, 12544
    s_and_b32 s92, s22, 7
    s_cmp_lt_u32 s22, 8
    s_cbranch_scc1 K_R
    s_setprio 2
    v_and_b32 v1, 0x30, v124
    v_xor_b32 v24, v125, v1
    v_lshlrev_b32 v1, 1, v1
    v_xor_b32 v104, v125, v1
    v_xor_b32 v105, 0x80, v104
    s_and_b32 s3, s92, 1
    s_lshl_b32 s3, s3, 7
    v_xor_b32 v24, s3, v24
    v_xor_b32 v25, 64, v24
    s_lshl_b32 s60, s92, 11
    s_lshl_b32 s61, s92, 12
    s_add_u32 s62, s61, 32768
    s_add_u32 m0, s60, 67584
    v_mov_b32 v26, 1
    s_waitcnt lgkmcnt(0)
    s_add_u32 s28, s4, s94
    s_addc_u32 s29, s5, 0
    s_mov_b32 s30, s95
    s_mov_b32 s31, 0x20000
    s_mov_b32 s24, s12
    s_mov_b32 s25, s13
    s_mov_b32 s26, 65536
    s_mov_b32 s27, 0x20000
    s_cmp_ge_u32 s92, 6
    s_cbranch_scc1 G_X67
    buffer_load_dwordx4 v24, s[28:31], s60 offen  lds
    buffer_load_dwordx4 v25, s[28:31], s60 offen offset:1024  lds
G_XD:
    s_add_u32 m0, s61, 2048
    s_barrier
    buffer_load_dwordx4 v104, s[24:27], s61 offen offset:0 lds
    buffer_load_dwordx4 v104, s[24:27], s61 offen offset:1024 lds
    buffer_load_dwordx4 v105, s[24:27], s61 offen offset:2048 lds
    buffer_load_dwordx4 v105, s[24:27], s61 offen offset:3072 lds
    s_setprio 0
    s_branch K_G
G_X67:
    s_cmp_eq_u32 s92, 7
    s_cbranch_scc1 G_X7
    s_mov_b32 exec_hi, 0
    buffer_load_dwordx4 v24, s[28:31], s60 offen  lds
    s_mov_b32 exec_hi, -1
    s_branch G_XD
G_X7:
    v_and_b32 v3, 0x380, v125
    v_and_b32 v1, 7, v124
    v_lshl_add_u32 v3, v1, 2, v3
    v_add_u32 v3, 65536, v3
    global_load_dword v92, v3, s[12:13] offset:0
    global_load_dword v93, v3, s[12:13] offset:32
    global_load_dword v94, v3, s[12:13] offset:64
    global_load_dword v95, v3, s[12:13] offset:96
    s_branch G_XD
R_IDLE:
    s_cmp_lg_u32 s22, 7
    s_cbranch_scc1 R_J00
    s_load_dword s59, s[20:21], 0
    s_mov_b32 s60, 3211136
    s_load_dword s53, s[20:21], s60
    s_mov_b32 s60, 5163264
    s_load_dword s53, s[20:21], s60
    s_mov_b32 s60, 7096064
    s_load_dword s53, s[20:21], s60
    s_load_dword s53, s[16:17], s94
    s_branch R_J0C
K_R:
    s_setprio 1
    s_mul_i32 s60, s2, 6400
    v_lshl_add_u32 v1, v0, 4, s60
    s_cmpk_lt_u32 s2, 250
    s_cselect_b32 s61, 400, 0
    v_cmp_gt_u32 s[54:55], s61, v0
    v_lshlrev_b32 v2, 1, v1
    s_cmp_ge_u32 s22, 4
    s_cbranch_scc1 R_NOZ0
    v_lshlrev_b32 v3, 2, v0
    v_add_u32 v46, 99648, v3
    ds_write_b32 v3, v127
    ds_write_b32 v46, v127
R_NOZ0:
    s_mov_b64 exec, s[54:55]
    s_waitcnt lgkmcnt(0)
    s_cbranch_execz R_IDLE
    global_load_dwordx4 v[4:7], v1, s[10:11]
R_J00:
    s_barrier
R_J0C:
    s_mov_b64 exec, -1
    s_add_u32 s36, s20, 3211264
    s_addc_u32 s37, s21, 0
    s_mov_b32 s38, 4832000
    s_mov_b32 s39, 0x20000
    v_mov_b32 v46, 1
    v_lshlrev_b32 v3, 4, v0
    v_add_u32 v50, 80448, v3
    s_mul_i32 s3, s2, 19328
    v_add_u32 v51, s3, v3
    v_mov_b32 v54, 0x40000000
    v_cmp_gt_u32 vcc, 304, v0
    s_movk_i32 s64, 7168
    s_movk_i32 s65, 14336
    v_cndmask_b32 v47, v54, v51, vcc
    s_lshr_b32 s3, s23, 5
    s_lshl_b32 s3, s3, 15
    s_add_u32 s3, s3, 8060928
    v_lshrrev_b32 v53, 1, v0
    v_lshl_add_u32 v58, v53, 7, s3
    s_bfe_u32 s3, s23, 0x30002
    s_lshl_b32 s3, s3, 4
    s_add_u32 s3, s3, 0
    v_add_u32 v52, s3, v58
    v_mul_u32_u24 v53, 19328, v53
    v_subrev_u32 v53, 80448, v53
    v_lshrrev_b32 v126, 2, v125
    s_mul_i32 s67, s22, 1280
    s_add_u32 s67, s67, 110464
    v_add_u32 v57, s67, v126
    ds_write2st64_b32 v57, v54, v54 offset0:0 offset1:1
    ds_write2st64_b32 v57, v54, v54 offset0:2 offset1:3
    ds_write_b32 v57, v54 offset:1024
    s_mov_b32 s66, 99648
    v_add_u32 v49, s66, v125
    s_movk_i32 s61, -196
    s_add_u32 s32, s20, 1024
    s_addc_u32 s33, s21, 0
    s_mov_b32 s34, 3203072
    s_mov_b32 s35, 0x20000
    v_and_b32 v108, 0xf0, v125
    s_lshl_b32 s3, s22, 6
    s_add_u32 s3, s3, 80384
    v_and_b32 v60, 0x30, v124
    v_add_u32 v112, s3, v60
    v_and_b32 v61, 3, v124
    v_lshlrev_b32 v111, 1, v60
    v_lshl_add_u32 v111, v61, 3, v111
    s_lshl_b32 s68, s22, 12
    s_add_u32 s68, s68, 2048
    s_lshl_b32 s3, s22, 4
    s_add_u32 s3, s3, 88064
    v_and_b32 v114, 12, v124
    v_lshl_add_u32 v109, v114, 6, v111
    v_add_u32 v114, s3, v114
    v_lshrrev_b32 v62, 5, v124
    v_lshl_add_u32 v113, v62, 3, s3
    v_lshrrev_b32 v110, 1, v125
    v_and_b32 v110, 0xf8, v110
    s_lshr_b32 s44, s22, 2
    s_and_b32 s45, s22, 3
    s_lshl_b32 s45, s45, 6
    s_mul_i32 s3, s44, 13568
    s_add_u32 s3, s3, 120704
    v_mul_u32_u24 v120, 53, v108
    v_add_u32 v120, s3, v120
    v_add_u32 v119, v120, v60
    v_lshrrev_b32 v63, 1, v60
    v_add3_u32 v120, v120, v63, s45
    s_add_u32 s3, s3, s45
    v_lshrrev_b32 v63, 2, v124
    v_mul_u32_u24 v121, 848, v63
    v_lshlrev_b32 v61, 4, v61
    v_add3_u32 v121, v121, v61, s3
    s_lshl_b32 s3, s44, 12
    s_add_u32 s3, s3, s45
    v_lshl_add_u32 v122, v63, 8, v61
    v_add_u32 v122, s3, v122
    s_mul_i32 s3, s22, 3392
    s_add_u32 s3, s3, 120704
    v_mul_u32_u24 v117, 53, v60
    v_add3_u32 v117, v117, v108, s3
    v_add_u32 v116, v117, v108
    v_and_b32 v61, 31, v124
    v_lshlrev_b32 v118, 3, v61
    v_and_b32 v61, 12, v124
    v_lshl_add_u32 v118, v61, 6, v118
    v_lshl_add_u32 v118, v60, 8, v118
    v_xor_b32 v118, s45, v118
    v_bfe_u32 v60, v124, 2, 1
    v_bfe_u32 v61, v124, 4, 1
    v_lshl_or_b32 v60, v60, 1, v61
    v_bfe_u32 v61, v124, 3, 1
    v_bfe_u32 v63, v124, 1, 1
    v_lshl_or_b32 v61, v61, 1, v63
    v_lshl_or_b32 v63, v60, 2, v61
    s_lshl_b32 s3, s22, 8
    s_add_u32 s3, s3, 89984
    v_lshl_add_u32 v115, v63, 4, s3
    v_lshl_or_b32 v60, v61, 2, v60
    v_and_b32 v61, 1, v124
    v_lshl_or_b32 v61, v61, 2, v62
    v_xor_b32 v61, v61, v63
    v_lshl_add_u32 v60, v60, 4, v61
    v_lshl_add_u32 v104, v60, 4, s68
    v_xor_b32 v105, 32, v104
    v_xor_b32 v106, 128, v104
    v_xor_b32 v107, 160, v104
    s_and_b32 s46, s22, 3
    s_lshr_b32 s44, s22, 2
    s_lshl_b32 s3, s44, 2
    s_add_u32 s3, s3, s46
    s_lshl_b32 s3, s3, 10
    s_lshl_b32 s45, s46, 6
    s_add_u32 s45, s45, 12288
    s_cmp_eq_u32 s44, 3
    s_cselect_b32 s3, s45, s3
    s_cselect_b32 s44, 4, 0
    s_add_u32 s3, s3, 67584
    v_lshrrev_b32 v60, s44, v125
    v_and_b32 v60, 0x3f0, v60
    v_add_u32 v123, s3, v60
    v_mov_b32 v84, 0
    v_mov_b32 v85, 0
    v_mov_b32 v86, 0
    v_mov_b32 v87, 0
    v_mov_b32 v88, 0
    v_mov_b32 v89, 0
    v_mov_b32 v90, 0
    v_mov_b32 v91, 0
    v_mov_b32 v92, 0
    v_mov_b32 v93, 0
    v_mov_b32 v94, 0
    v_mov_b32 v95, 0
    v_and_b32 v60, 0x30, v125
    s_movk_i32 s44, 0x3f80
    s_mov_b32 s45, 0
    s_mov_b32 exec_lo, 0xf
    s_mov_b32 exec_hi, 0xf00
    v_lshlrev_b64 v[84:85], v60, s[44:45]
    s_mov_b32 exec_lo, 0xf0
    s_mov_b32 exec_hi, 0xf000
    v_lshlrev_b64 v[86:87], v60, s[44:45]
    s_mov_b32 exec_lo, 0xf0000
    s_mov_b32 exec_hi, 0xf000000
    v_lshlrev_b64 v[88:89], v60, s[44:45]
    s_mov_b32 exec_lo, 0xf00000
    s_mov_b32 exec_hi, 0xf0000000
    v_lshlrev_b64 v[90:91], v60, s[44:45]
    s_mov_b64 exec, -1
    s_movk_i32 s56, 3072
    s_movk_i32 s57, 2048
    s_movk_i32 s58, 1024
    s_mov_b32 s98, 0x55555555
    s_mov_b32 s99, 0xaaaaaaaa
    s_bitcmp1_b32 s23, 1
    s_cselect_b64 s[46:47], -1, 0
    s_and_b32 s48, s23, 1
    s_lshl_b32 s48, s48, 4
    s_cmp_eq_u32 s22, 7
    s_cbranch_scc1 R_WARM
    s_mov_b64 exec, s[54:55]
    s_cbranch_execz R_J01
    global_load_dwordx4 v[8:11], v1, s[8:9]
    global_load_dwordx4 v[12:15], v2, s[6:7]
    global_load_dwordx4 v[16:19], v2, s[6:7] offset:16
R_J01:
    s_waitcnt vmcnt(3)
    v_mul_u32_u24 v28, 21400, v4
    v_lshrrev_b32 v28, 20, v28
    v_lshl_add_u32 v20, v28, 2, s66
    ds_add_rtn_u32 v24, v20, v46
    v_mul_u32_u24 v29, 21400, v5
    v_lshrrev_b32 v29, 20, v29
    v_lshl_add_u32 v21, v29, 2, s66
    ds_add_rtn_u32 v25, v21, v46
    v_mul_u32_u24 v30, 21400, v6
    v_lshrrev_b32 v30, 20, v30
    v_lshl_add_u32 v22, v30, 2, s66
    ds_add_rtn_u32 v26, v22, v46
    v_mul_u32_u24 v31, 21400, v7
    v_lshrrev_b32 v31, 20, v31
    v_lshl_add_u32 v23, v31, 2, s66
    ds_add_rtn_u32 v27, v23, v46
    s_mov_b64 exec, 1
    ds_add_u32 v127, v46 offset:256
    s_mov_b64 exec, -1
R_SY1:
    ds_read_b32 v32, v127 offset:256
    ds_read_b128 v[36:39], v49
    s_waitcnt lgkmcnt(0)
    v_cmp_ne_u32 vcc, 7, v32
    s_cbranch_vccnz R_SY1
    v_add_u32 v42, v36, v37
    v_add_u32 v43, v42, v38
    v_add_u32 v45, v43, v39
    v_subrev_u32 v44, 6704, v45
    v_lshlrev_b32 v4, 2, v4
    v_lshlrev_b32 v5, 2, v5
    v_add_u32_dpp v45, v45, v45 row_shr:1 row_mask:0xf bank_mask:0xf
    v_lshlrev_b32 v6, 2, v6
    v_lshlrev_b32 v7, 2, v7
    v_add_u32_dpp v45, v45, v45 row_shr:2 row_mask:0xf bank_mask:0xf
    v_mad_i32_i24 v28, v28, s61, v4
    v_mad_i32_i24 v29, v29, s61, v5
    v_add_u32_dpp v45, v45, v45 row_shr:4 row_mask:0xf bank_mask:0xf
    v_mad_i32_i24 v30, v30, s61, v6
    v_mad_i32_i24 v31, v31, s61, v7
    v_add_u32_dpp v45, v45, v45 row_shr:8 row_mask:0xf bank_mask:0xf
    s_nop 1
    v_add_u32_dpp v45, v45, v45 row_bcast:15 row_mask:0xa bank_mask:0xf
    s_nop 1
    v_add_u32_dpp v45, v45, v45 row_bcast:31 row_mask:0xc bank_mask:0xf
    v_sub_u32 v40, v45, v44
    v_add_u32 v41, v40, v36
    v_add_u32 v42, v40, v42
    v_add_u32 v43, v40, v43
    s_cmp_eq_u32 s22, 7
    s_cbranch_scc1 R_PUB
    ds_write_b128 v49, v[40:43] offset:1024
    s_mov_b64 exec, s[54:55]
    ds_read_b32 v4, v20 offset:1024
    ds_read_b32 v5, v21 offset:1024
    ds_read_b32 v6, v22 offset:1024
    ds_read_b32 v7, v23 offset:1024
    s_waitcnt lgkmcnt(3)
    v_add_u32 v4, v4, v24
    v_mul_u32_u24 v4, 12, v4
    s_waitcnt lgkmcnt(2)
    v_add_u32 v5, v5, v25
    v_mul_u32_u24 v5, 12, v5
    s_waitcnt lgkmcnt(1)
    v_add_u32 v6, v6, v26
    v_mul_u32_u24 v6, 12, v6
    s_waitcnt lgkmcnt(0)
    v_add_u32 v7, v7, v27
    v_mul_u32_u24 v7, 12, v7
    s_waitcnt vmcnt(2)
    v_lshl_or_b32 v28, v8, 8, v28
    ds_write_b32 v4, v28 offset:8
    v_lshl_or_b32 v29, v9, 8, v29
    ds_write_b32 v5, v29 offset:8
    v_lshl_or_b32 v30, v10, 8, v30
    ds_write_b32 v6, v30 offset:8
    v_lshl_or_b32 v31, v11, 8, v31
    ds_write_b32 v7, v31 offset:8
    s_waitcnt vmcnt(1)
    ds_write2_b32 v4, v12, v13 offset0:0 offset1:1
    ds_write2_b32 v5, v14, v15 offset0:0 offset1:1
    s_waitcnt vmcnt(0)
    ds_write2_b32 v6, v16, v17 offset0:0 offset1:1
    ds_write2_b32 v7, v18, v19 offset0:0 offset1:1
    s_mov_b64 exec, 1
    ds_add_u32 v127, v46 offset:260
    s_mov_b64 exec, -1
R_SY2:
    ds_read_b32 v32, v127 offset:260
    s_waitcnt lgkmcnt(0)
    v_cmp_ne_u32 vcc, 7, v32
    s_cbranch_vccnz R_SY2
    ds_read_b128 v[4:7], v50
    ds_read_b128 v[8:11], v50 offset:7168
    ds_read_b128 v[12:15], v50 offset:14336
    s_waitcnt lgkmcnt(2)
    buffer_store_dwordx4 v[4:7], v51, s[36:39], 0 offen sc1
    s_waitcnt lgkmcnt(1)
    buffer_store_dwordx4 v[8:11], v51, s[36:39], s64 offen sc1
    s_waitcnt lgkmcnt(0)
    buffer_store_dwordx4 v[12:15], v47, s[36:39], s65 offen sc1
R_B3:
    v_and_b32 v72, 0x30, v124
    v_lshlrev_b32 v72, 2, v72
    v_xor_b32 v72, v72, v108
    v_xor_b32 v73, 16, v72
    v_xor_b32 v74, 32, v72
    v_xor_b32 v75, 48, v72
    s_lshl_b32 s3, s2, 7
    s_add_u32 s3, s3, 8060928
    v_and_b32 v59, 0x380, v125
    v_mul_u32_u24 v59, 255, v59
    v_add3_u32 v59, v59, v125, s3
    s_mov_b32 s40, s14
    s_mov_b32 s41, s15
    s_mov_b32 s42, 65536
    s_mov_b32 s43, 0x20000
    v_and_b32 v60, 0x30, v124
    v_lshlrev_b32 v60, 1, v60
    v_xor_b32 v60, v125, v60
    v_xor_b32 v61, 0x80, v60
    s_lshl_b32 s60, s22, 12
    s_add_u32 m0, s60, 2048
    s_bfe_u32 s3, s2, 0x30003
    s_lshl_b32 s3, s3, 5
    s_lshl_b32 s49, s22, 2
    s_add_u32 s3, s3, s49
    s_lshr_b32 s49, s2, 6
    s_add_u32 s3, s3, s49
    s_mul_i32 s3, s3, 12544
    s_add_u32 s3, s3, 3072
    v_lshl_add_u32 v70, v125, 3, s3
    v_add_u32 v38, 101696, v125
    s_waitcnt vmcnt(0)
    s_mov_b64 exec, 1
    ds_add_rtn_u32 v36, v127, v46 offset:288
    s_mov_b64 exec, -1
    ds_read_b128 v[32:35], v38
    ds_read_b32 v37, v127 offset:308
    s_waitcnt lgkmcnt(2)
    v_readfirstlane_b32 s3, v36
    s_cmp_lg_u32 s3, 15
    s_waitcnt lgkmcnt(0)
    s_cbranch_scc1 FIN59
    v_or_b32 v35, v35, v37
    global_store_dwordx4 v59, v[32:35], s[20:21] sc1
    s_mov_b64 exec, 1
    ds_add_u32 v127, v46 offset:288
    s_mov_b64 exec, -1
FIN59:
R_SY4:
    s_sleep 1
    ds_read2_b32 v[40:41], v127 offset0:72 offset1:76
    s_waitcnt lgkmcnt(0)
    v_cmp_ne_u32 vcc, 17, v40
    s_cbranch_vccnz R_SY4
    buffer_load_dwordx4 v60, s[40:43], s60 offen offset:0 lds
    buffer_load_dwordx4 v60, s[40:43], s60 offen offset:1024 lds
    buffer_load_dwordx4 v61, s[40:43], s60 offen offset:2048 lds
    buffer_load_dwordx4 v61, s[40:43], s60 offen offset:3072 lds
    s_mov_b32 exec_lo, 0xfff
    s_mov_b32 exec_hi, 0x0
    buffer_load_dword v69, v70, s[32:35], 0 offen offset:3072 sc1
    s_mov_b64 exec, -1
    v_bfe_u32 v4, v124, 2, 2
    v_lshlrev_b32 v4, 4, v4
    v_lshlrev_b64 v[64:65], v4, s[44:45]
    v_mov_b32 v66, 0
    v_mov_b32 v67, 0
    v_subrev_u32 v4, 64, v50
    ds_write_b128 v4, v[64:67] offset:9600
    ds_write_b128 v4, v[64:67] offset:17792
    s_cmp_ge_u32 s22, 4
    s_cbranch_scc1 R_NOE3
    ds_write_b128 v4, v[64:67] offset:25984
R_NOE3:
    v_mov_b32 v6, v54
    v_mov_b32 v7, v54
    v_mov_b32 v8, 162256
    v_lshlrev_b32 v5, 2, v0
    v_add_u32 v5, 88064, v5
    v_cmpx_gt_u32 vcc, 480, v0
    ds_write2_b64 v4, v[6:7], v[6:7] offset0:0 offset1:1
    ds_write_b32 v5, v8
    s_mov_b64 exec, -1
    v_lshrrev_b32 v4, 5, v0
    v_mul_u32_u24 v4, 848, v4
    v_lshl_add_u32 v4, v110, 1, v4
    v_add_u32 v4, 120704, v4
    ds_write_b128 v4, v[92:95]
    ds_write_b128 v4, v[92:95] offset:13568
    ds_write_b128 v4, v[92:95] offset:27136
    s_cmp_lg_u32 s22, 0
    s_cbranch_scc1 R_NOZ3
    ds_write_b128 v4, v[92:95] offset:40704
R_NOZ3:
    v_add_u32 v68, s67, v125
    s_waitcnt vmcnt(1)
    s_mov_b64 exec, 1
    ds_add_u32 v127, v46 offset:284
    s_mov_b64 exec, -1
    global_load_dwordx4 v[20:23], v52, s[20:21] sc1
    v_readfirstlane_b32 s59, v41
    s_mov_b32 s3, 262144
    s_mov_b32 vcc_lo, 0xaaaaaaaa
    s_mov_b32 vcc_hi, 0xaaaaaaaa
    s_mov_b64 s[50:51], -1
    s_waitcnt vmcnt(0)
R_POLL:
    v_cmpx_ne_u32 s[44:45], s59, v20
    s_cbranch_execnz R_RETRY
R_POLLED:
    s_mov_b64 exec, -1
    v_cndmask_b32 v21, v21, v22, s[46:47]
    v_cndmask_b32 v22, v22, v23, s[46:47]
    v_mov_b32 v36, v23
    v_alignbit_b32 v21, v22, v21, s48
    v_and_b32 v22, 0xffff, v21
    v_lshrrev_b32 v55, 16, v21
    v_sub_u32 v55, v55, v22
    v_add_u32 v23, 1, v55
    v_lshrrev_b32 v23, 1, v23
    v_sub_u32 v24, v55, v23
    v_cndmask_b32 v24, v23, v24, vcc
    v_mov_b32 v25, v24
    v_cndmask_b32 v23, 0, v23, vcc
    v_mad_u32_u24 v56, v22, 12, v53
    v_add_u32_dpp v25, v25, v25 row_shr:1 row_mask:0xf bank_mask:0xf
    v_mad_u32_u24 v22, v23, 12, v56
    v_add_u32 v26, 12, v22
    v_add_u32_dpp v25, v25, v25 row_shr:2 row_mask:0xf bank_mask:0xf
    v_add_u32 v27, 24, v22
    v_add_u32 v33, 36, v22
    v_add_u32_dpp v25, v25, v25 row_shr:4 row_mask:0xf bank_mask:0xf
    v_add_u32 v34, 48, v22
    v_add_u32 v35, 60, v22
    v_add_u32_dpp v25, v25, v25 row_shr:8 row_mask:0xf bank_mask:0xf
    s_nop 1
    v_add_u32_dpp v25, v25, v25 row_bcast:15 row_mask:0xa bank_mask:0xf
    s_nop 1
    v_add_u32_dpp v25, v25, v25 row_bcast:31 row_mask:0xc bank_mask:0xf
    s_nop 0
    v_readlane_b32 s63, v25, 63
    v_sub_u32 v25, v25, v24
    v_lshl_add_u32 v25, v25, 2, s67
    s_cmpk_gt_u32 s63, 320
    s_cbranch_scc1 R_OVF
    v_cmpx_lt_u32 vcc, 0, v24
    ds_write_b32 v25, v22 offset:0
    v_cmpx_lt_u32 vcc, 1, v24
    ds_write_b32 v25, v26 offset:4
    v_cmpx_lt_u32 vcc, 2, v24
    ds_write_b32 v25, v27 offset:8
    v_cmpx_lt_u32 vcc, 3, v24
    ds_write_b32 v25, v33 offset:12
    v_cmpx_lt_u32 vcc, 4, v24
    ds_write_b32 v25, v34 offset:16
    v_cmpx_lt_u32 vcc, 5, v24
    ds_write_b32 v25, v35 offset:20
    v_cmpx_lt_u32 vcc, 6, v24
    s_cbranch_execnz R_EXP
R_EXPD:
    s_mov_b64 exec, -1
    ds_read_b32 v32, v57 offset:1024
    ds_read_b32 v31, v57 offset:768
    ds_read_b32 v30, v57 offset:512
    ds_read_b32 v29, v57 offset:256
    ds_read_b32 v28, v57 offset:0
    s_cmpk_le_u32 s63, 256
    s_cbranch_scc1 R_LD3
    s_waitcnt lgkmcnt(4)
    buffer_load_dwordx3 v[20:22], v32, s[36:39], 0 offen sc1
R_LD3:
    s_waitcnt lgkmcnt(3)
    buffer_load_dwordx3 v[16:18], v31, s[36:39], 0 offen sc1
    s_waitcnt lgkmcnt(2)
    buffer_load_dwordx3 v[12:14], v30, s[36:39], 0 offen sc1
    s_waitcnt lgkmcnt(1)
    buffer_load_dwordx3 v[8:10], v29, s[36:39], 0 offen sc1
    s_waitcnt lgkmcnt(0)
    buffer_load_dwordx3 v[4:6], v28, s[36:39], 0 offen sc1
    ds_write_b128 v68, v[64:67]
    s_mov_b64 exec, 0xffff
    ds_write_b128 v68, v[64:67] offset:1024
    s_mov_b64 exec, -1
    v_cmp_ne_u32 s[52:53], v54, v32
    v_cmp_ne_u32 s[50:51], v54, v31
    v_cmp_ne_u32 s[48:49], v54, v30
    v_cmp_ne_u32 s[46:47], v54, v29
    v_cmp_ne_u32 s[44:45], v54, v28
    v_bfe_u32 v24, v36, 16, 8
    v_lshrrev_b32 v25, 24, v36
    s_nop 0
    v_max_u32_dpp v24, v24, v24 row_shr:1 row_mask:0xf bank_mask:0xf
    v_max_u32_dpp v25, v25, v25 row_shr:1 row_mask:0xf bank_mask:0xf
    s_nop 0
    v_max_u32_dpp v24, v24, v24 row_shr:2 row_mask:0xf bank_mask:0xf
    v_max_u32_dpp v25, v25, v25 row_shr:2 row_mask:0xf bank_mask:0xf
    s_nop 0
    v_max_u32_dpp v24, v24, v24 row_shr:4 row_mask:0xf bank_mask:0xf
    v_max_u32_dpp v25, v25, v25 row_shr:4 row_mask:0xf bank_mask:0xf
    s_nop 0
    v_max_u32_dpp v24, v24, v24 row_shr:8 row_mask:0xf bank_mask:0xf
    v_max_u32_dpp v25, v25, v25 row_shr:8 row_mask:0xf bank_mask:0xf
    s_nop 0
    v_max_u32_dpp v24, v24, v24 row_bcast:15 row_mask:0xa bank_mask:0xf
    v_max_u32_dpp v25, v25, v25 row_bcast:15 row_mask:0xa bank_mask:0xf
    s_nop 0
    v_max_u32_dpp v24, v24, v24 row_bcast:31 row_mask:0xc bank_mask:0xf
    v_max_u32_dpp v25, v25, v25 row_bcast:31 row_mask:0xc bank_mask:0xf
    s_mov_b32 exec_lo, 0
    s_mov_b32 exec_hi, 0x80000000
    v_cmp_eq_u32 vcc, 0xff, v24
    v_add_u32 v24, 856, v24
    v_add_u32 v25, 856, v25
    v_lshlrev_b32 v24, 20, v24
    v_lshlrev_b32 v25, 20, v25
    v_cndmask_b32 v24, v24, -1, vcc
    ds_max_u32 v127, v25 offset:276
    ds_max_u32 v127, v24 offset:280
    s_cbranch_scc1 R_H3
    s_mov_b64 exec, s[52:53]
    s_waitcnt vmcnt(4)
    v_and_b32 v32, 0xfc, v22
    ds_add_rtn_u32 v23, v32, v46 offset:0
R_H3:
    s_mov_b64 exec, s[50:51]
    s_waitcnt vmcnt(3)
    v_and_b32 v31, 0xfc, v18
    ds_add_rtn_u32 v19, v31, v46 offset:0
    s_mov_b64 exec, s[48:49]
    s_waitcnt vmcnt(2)
    v_and_b32 v30, 0xfc, v14
    ds_add_rtn_u32 v15, v30, v46 offset:0
    s_mov_b64 exec, s[46:47]
    s_waitcnt vmcnt(1)
    v_and_b32 v29, 0xfc, v10
    ds_add_rtn_u32 v11, v29, v46 offset:0
    s_mov_b64 exec, s[44:45]
    s_waitcnt vmcnt(0)
    v_and_b32 v28, 0xfc, v6
    ds_add_rtn_u32 v7, v28, v46 offset:0
    s_mov_b64 exec, -1
    s_mov_b32 s60, s63
    s_movk_i32 s61, 0xff00
    v_and_b32 v22, s61, v22
    v_and_b32 v18, s61, v18
    v_and_b32 v14, s61, v14
    v_and_b32 v10, s61, v10
    v_and_b32 v6, s61, v6
    s_waitcnt lgkmcnt(0)
    s_barrier
    ds_read_b32 v36, v126 offset:0
    s_mov_b32 exec_lo, 0xffff
    s_mov_b32 exec_hi, 0x0
    buffer_load_dword v69, v70, s[32:35], 0 offen sc1
    s_mov_b64 exec, -1
    v_lshrrev_b32 v64, 2, v23
    v_lshrrev_b32 v63, 2, v19
    v_lshrrev_b32 v62, 2, v15
    v_lshrrev_b32 v61, 2, v11
    v_lshrrev_b32 v60, 2, v7
    s_waitcnt lgkmcnt(0)
    v_add_u32 v33, 3, v36
    v_and_b32 v34, 4, v33
    v_and_b32 v37, -8, v33
    v_lshl_or_b32 v37, v34, 16, v37
    v_mov_b32 v35, v37
    v_cmp_ne_u32 vcc, 0, v34
    v_lshrrev_b32 v33, 2, v33
    v_add_u32_dpp v37, v37, v37 row_shr:1 row_mask:0xf bank_mask:0xf
    v_subrev_u32 v34, 4096, v34
    v_min_u32 v64, 1, v64
    v_add_u32_dpp v37, v37, v37 row_shr:2 row_mask:0xf bank_mask:0xf
    v_min_u32 v63, 1, v63
    v_min_u32 v62, 1, v62
    v_add_u32_dpp v37, v37, v37 row_shr:4 row_mask:0xf bank_mask:0xf
    v_min_u32 v61, 1, v61
    v_min_u32 v60, 1, v60
    v_add_u32_dpp v37, v37, v37 row_shr:8 row_mask:0xf bank_mask:0xf
    v_lshlrev_b32 v64, 4, v64
    v_lshlrev_b32 v63, 4, v63
    v_add_u32_dpp v37, v37, v37 row_bcast:15 row_mask:0xa bank_mask:0xf
    v_lshlrev_b32 v62, 4, v62
    v_lshlrev_b32 v61, 4, v61
    v_add_u32_dpp v37, v37, v37 row_bcast:31 row_mask:0xc bank_mask:0xf
    v_lshlrev_b32 v60, 4, v60
    v_readlane_b32 s63, v37, 63
    v_sub_u32 v37, v37, v35
    v_lshrrev_b32 v35, 16, v37
    v_and_b32 v37, 0xffff, v37
    s_add_u32 s54, s63, 8
    s_and_b32 s54, s54, 0xfff0
    s_add_u32 s3, s54, 4096
    v_sub_u32 v37, v37, v34
    v_add_u32 v35, s3, v35
    v_cndmask_b32 v35, v37, v35, vcc
    v_lshl_or_b32 v37, v37, 16, v35
    ds_bpermute_b32 v42, v32, v37
    ds_bpermute_b32 v41, v31, v37
    ds_bpermute_b32 v40, v30, v37
    ds_bpermute_b32 v39, v29, v37
    ds_bpermute_b32 v38, v28, v37
    s_lshr_b32 s63, s63, 16
    s_add_u32 s63, s63, s54
    s_lshr_b32 s63, s63, 2
    s_cmpk_gt_u32 s63, 480
    s_cbranch_scc1 K_JOIN
    s_cmpk_le_u32 s60, 256
    s_waitcnt lgkmcnt(0)
    s_cbranch_scc1 R_S3
    s_mov_b64 exec, s[52:53]
    v_bfe_u32 v42, v42, v64, 16
    v_add_lshl_u32 v42, v42, v23, 4
    v_lshrrev_b32 v44, 2, v42
    ds_write_b32 v44, v22 offset:64000
R_S3:
    s_mov_b64 exec, s[50:51]
    v_bfe_u32 v41, v41, v63, 16
    v_add_lshl_u32 v41, v41, v19, 4
    v_lshrrev_b32 v44, 2, v41
    ds_write_b32 v44, v18 offset:64000
    s_mov_b64 exec, s[48:49]
    v_bfe_u32 v40, v40, v62, 16
    v_add_lshl_u32 v40, v40, v15, 4
    v_lshrrev_b32 v44, 2, v40
    ds_write_b32 v44, v14 offset:64000
    s_mov_b64 exec, s[46:47]
    v_bfe_u32 v39, v39, v61, 16
    v_add_lshl_u32 v39, v39, v11, 4
    v_lshrrev_b32 v44, 2, v39
    ds_write_b32 v44, v10 offset:64000
    s_mov_b64 exec, s[44:45]
    v_bfe_u32 v38, v38, v60, 16
    v_add_lshl_u32 v38, v38, v7, 4
    v_lshrrev_b32 v44, 2, v38
    ds_write_b32 v44, v6 offset:64000
    s_mov_b64 exec, -1
K_JOIN:
    s_mov_b32 m0, s68
    s_cmpk_gt_u32 s63, 480
    s_waitcnt lgkmcnt(0)
    s_barrier
    ds_read_b128 v[100:103], v112
    s_waitcnt lgkmcnt(0)
    v_lshl_add_u64 v[100:101], v[100:101], 0, v[72:73]
    v_lshl_add_u64 v[102:103], v[102:103], 0, v[74:75]
    buffer_load_dwordx4 v100, s[32:35], s56 offen offset:0 sc1 lds
    buffer_load_dwordx4 v101, s[32:35], s57 offen offset:1024 sc1 lds
    buffer_load_dwordx4 v102, s[32:35], s58 offen offset:2048 sc1 lds
    buffer_load_dwordx4 v103, s[32:35], 0 offen offset:3072 sc1 lds
    s_cbranch_scc1 R_NOEW
    s_mov_b64 exec, s[52:53]
    ds_write_b64 v42, v[20:21] offset:24456
    s_mov_b64 exec, s[50:51]
    ds_write_b64 v41, v[16:17] offset:24456
    s_mov_b64 exec, s[48:49]
    ds_write_b64 v40, v[12:13] offset:24456
    s_mov_b64 exec, s[46:47]
    ds_write_b64 v39, v[8:9] offset:24456
    s_mov_b64 exec, s[44:45]
    ds_write_b64 v38, v[4:5] offset:24456
    s_mov_b64 exec, -1
R_NOEW:
    s_waitcnt lgkmcnt(0)
    s_barrier
K_POSTD:
    s_setprio 3
    ds_read_b96 v[28:30], v127 offset:272
    ds_read_b32 v97, v114
    ds_read_b128 v[100:103], v112 offset:1024
    ds_read_b64_tr_b16 v[78:79], v109 offset:1024
    ds_read_b64_tr_b16 v[82:83], v109 offset:1152
    s_or_b32 s3, s2, s22
    s_cbranch_scc1 K_NOEP
    v_mov_b32 v27, s59
    global_store_dword v127, v27, s[20:21] sc0 sc1
K_NOEP:
    s_add_u32 s62, s63, 63
    s_lshr_b32 s62, s62, 2
    s_sub_u32 s62, s62, s22
    s_lshr_b32 s62, s62, 4
    s_movk_i32 s46, 1024
    s_movk_i32 s47, 256
    s_movk_i32 s48, 256
    s_movk_i32 s49, 4096
    v_add_u32 v112, 2048, v112
    v_add_u32 v114, 256, v114
    s_waitcnt lgkmcnt(4)
    v_add_f32 v29, v29, v29
    v_fma_f32 v28, v28, v30, v29
    s_mov_b32 s69, 1
    v_readfirstlane_b32 s61, v28
    s_cmpk_gt_u32 s63, 480
    s_cbranch_scc1 K_SLOW
    s_cmp_gt_u32 s61, 0x41f00000
    s_cbranch_scc1 K_SLOW
    s_mov_b32 s69, 0
    s_cmp_gt_u32 s61, 0x41680000
    s_cselect_b32 s54, 0, s54
    s_lshr_b32 s61, s61, 23
    s_max_u32 s61, s61, 107
    s_sub_u32 s3, s61, 18
    s_lshl_b32 s64, s3, 23
    s_mov_b32 s65, s64
    s_add_u32 s60, s64, 0xbc00000
    s_mov_b32 s61, s60
    s_lshr_b32 s3, s54, 4
    s_add_u32 s3, s3, 15
    s_sub_u32 s3, s3, s22
    s_lshr_b32 s3, s3, 4
    s_sub_u32 s55, s62, s3
    s_cmp_eq_u32 s22, 12
    s_waitcnt lgkmcnt(2)
    v_add_u32 v97, v97, v111
    v_lshl_add_u64 v[100:101], v[100:101], 0, v[72:73]
    v_lshl_add_u64 v[102:103], v[102:103], 0, v[74:75]
    s_cbranch_scc1 G_COR
K_CORD:
    s_waitcnt vmcnt(0)
    ds_read_b128 v[0:3], v104
    ds_read_b128 v[4:7], v105
    ds_read_b64_tr_b16 v[76:77], v97 offset:512
    s_mov_b64 exec, s[98:99]
    ds_read_b128 v[92:95], v115
    s_mov_b64 exec, -1
    ds_read_b128 v[8:11], v106
    ds_read_b128 v[12:15], v107
    ds_read_b64_tr_b16 v[80:81], v97 offset:640
    s_cmp_gt_u32 s62, 1
    s_waitcnt lgkmcnt(0)
    s_cbranch_scc0 K_FEW
    buffer_load_dwordx4 v100, s[32:35], s56 offen offset:0 sc1 lds
    buffer_load_dwordx4 v101, s[32:35], s57 offen offset:1024 sc1 lds
    buffer_load_dwordx4 v102, s[32:35], s58 offen offset:2048 sc1 lds
    buffer_load_dwordx4 v103, s[32:35], 0 offen offset:3072 sc1 lds
K_PRE2:
    v_mfma_f32_32x32x16_bf16 v[16:31], v[0:3], v[84:87], 0
    v_mfma_f32_32x32x16_bf16 v[16:31], v[4:7], v[88:91], v[16:31]
    v_mfma_f32_32x32x16_bf16 v[16:31], v[92:95], v[76:79], v[16:31]
    ds_read_b128 v[100:103], v112
    ds_read_b32 v99, v114
    ds_read_b32 v98, v113
    v_lshl_add_u64 v[112:113], v[112:113], 0, s[46:47]
    v_lshl_add_u64 v[114:115], v[114:115], 0, s[48:49]
    s_cmp_eq_u32 s62, s55
    s_waitcnt lgkmcnt(0)
    s_nop 3
    s_cbranch_scc1 K_TOQ
.p2align 3
K_LOOPO:
    v_mfma_f32_32x32x16_bf16 v[32:47], v[8:11], v[84:87], 0
    v_exp_f32 v48, v16
    v_exp_f32 v49, v17
    v_exp_f32 v50, v18
    s_waitcnt lgkmcnt(1)
    v_lshl_add_u64 v[96:97], v[98:99], 0, v[110:111]
    v_lshl_add_u64 v[100:101], v[100:101], 0, v[72:73]
    v_lshl_add_u64 v[102:103], v[102:103], 0, v[74:75]
    v_exp_f32 v51, v19
    v_exp_f32 v52, v20
    v_mfma_f32_32x32x16_bf16 v[32:47], v[12:15], v[88:91], v[32:47]
    v_exp_f32 v53, v21
    v_exp_f32 v54, v22
    v_exp_f32 v55, v23
    v_exp_f32 v56, v24
    v_exp_f32 v57, v25
    v_mfma_f32_32x32x16_bf16 v[32:47], v[92:95], v[80:83], v[32:47]
    v_exp_f32 v58, v26
    v_exp_f32 v59, v27
    v_exp_f32 v60, v28
    v_exp_f32 v61, v29
    v_exp_f32 v62, v30
    v_exp_f32_e64 v63, v31
    v_pk_add_f32 v[64:65], v[48:49], 1.0 op_sel_hi:[1,0]
    v_pk_fma_f32 v[68:69], v[16:17], v[50:51], v[16:17]
    v_pk_fma_f32 v[68:69], v[18:19], v[64:65], v[68:69]
    v_pk_fma_f32 v[64:65], v[64:65], v[50:51], v[64:65]
    v_pk_fma_f32 v[68:69], v[68:69], v[52:53], v[68:69]
    v_pk_fma_f32 v[68:69], v[20:21], v[64:65], v[68:69]
    v_pk_fma_f32 v[64:65], v[64:65], v[52:53], v[64:65]
    v_pk_fma_f32 v[68:69], v[68:69], v[54:55], v[68:69]
    v_pk_fma_f32 v[68:69], v[22:23], v[64:65], v[68:69]
    v_pk_fma_f32 v[64:65], v[64:65], v[54:55], v[64:65]
    v_pk_fma_f32 v[68:69], v[68:69], v[56:57], v[68:69]
    v_pk_fma_f32 v[68:69], v[24:25], v[64:65], v[68:69]
    v_pk_fma_f32 v[64:65], v[64:65], v[56:57], v[64:65]
    v_pk_fma_f32 v[68:69], v[68:69], v[58:59], v[68:69]
    v_pk_fma_f32 v[68:69], v[26:27], v[64:65], v[68:69]
    v_pk_fma_f32 v[64:65], v[64:65], v[58:59], v[64:65]
    v_pk_fma_f32 v[68:69], v[68:69], v[60:61], v[68:69]
    v_pk_fma_f32 v[68:69], v[28:29], v[64:65], v[68:69]
    v_pk_fma_f32 v[64:65], v[64:65], v[60:61], v[64:65]
    v_pk_fma_f32 v[68:69], v[68:69], v[62:63], v[68:69]
    v_pk_fma_f32 v[66:67], v[64:65], v[62:63], v[64:65]
    v_rcp_f32 v66, v66
    s_waitcnt vmcnt(0)
    ds_read_b128 v[0:3], v104
    ds_read_b128 v[4:7], v105
    ds_read_b64_tr_b16 v[76:77], v97 offset:512
    s_mov_b64 exec, s[98:99]
    ds_read_b128 v[92:95], v115
    s_mov_b64 exec, -1
    ds_read_b128 v[8:11], v106
    ds_read_b128 v[12:15], v107
    ds_read_b64_tr_b16 v[80:81], v97 offset:640
    v_rcp_f32_e64 v67, v67
    v_pk_fma_f32 v[68:69], v[30:31], v[64:65], v[68:69]
    v_pk_fma_f32 v[62:63], v[68:69], v[66:67], s[60:61]
    ds_add_u64 v96, v[62:63] offset:0
    s_waitcnt lgkmcnt(1)
    v_mfma_f32_32x32x16_bf16 v[16:31], v[0:3], v[84:87], 0
    v_exp_f32 v48, v32
    v_exp_f32 v49, v33
    v_exp_f32 v50, v34
    v_exp_f32 v51, v35
    v_exp_f32 v52, v36
    s_cmp_gt_u32 s62, 2
    s_cbranch_scc0 K_NODMAO
    buffer_load_dwordx4 v100, s[32:35], s56 offen offset:0 sc1 lds
    buffer_load_dwordx4 v101, s[32:35], s57 offen offset:1024 sc1 lds
    buffer_load_dwordx4 v102, s[32:35], s58 offen offset:2048 sc1 lds
    buffer_load_dwordx4 v103, s[32:35], 0 offen offset:3072 sc1 lds
K_BACKO:
    ds_read_b128 v[100:103], v112
    ds_read_b32 v99, v114
    ds_read_b32 v98, v113
    v_lshl_add_u64 v[112:113], v[112:113], 0, s[46:47]
    v_lshl_add_u64 v[114:115], v[114:115], 0, s[48:49]
    v_mfma_f32_32x32x16_bf16 v[16:31], v[4:7], v[88:91], v[16:31]
    v_exp_f32 v53, v37
    v_exp_f32 v54, v38
    v_exp_f32 v55, v39
    v_exp_f32 v56, v40
    v_exp_f32 v57, v41
    v_mfma_f32_32x32x16_bf16 v[16:31], v[92:95], v[76:79], v[16:31]
    v_exp_f32 v58, v42
    v_exp_f32 v59, v43
    v_exp_f32 v60, v44
    v_exp_f32 v61, v45
    v_exp_f32 v62, v46
    v_exp_f32_e64 v63, v47
    v_pk_add_f32 v[64:65], v[48:49], 1.0 op_sel_hi:[1,0]
    v_pk_fma_f32 v[68:69], v[32:33], v[50:51], v[32:33]
    v_pk_fma_f32 v[68:69], v[34:35], v[64:65], v[68:69]
    v_pk_fma_f32 v[64:65], v[64:65], v[50:51], v[64:65]
    v_pk_fma_f32 v[68:69], v[68:69], v[52:53], v[68:69]
    v_pk_fma_f32 v[68:69], v[36:37], v[64:65], v[68:69]
    v_pk_fma_f32 v[64:65], v[64:65], v[52:53], v[64:65]
    v_pk_fma_f32 v[68:69], v[68:69], v[54:55], v[68:69]
    v_pk_fma_f32 v[68:69], v[38:39], v[64:65], v[68:69]
    v_pk_fma_f32 v[64:65], v[64:65], v[54:55], v[64:65]
    v_pk_fma_f32 v[68:69], v[68:69], v[56:57], v[68:69]
    v_pk_fma_f32 v[68:69], v[40:41], v[64:65], v[68:69]
    v_pk_fma_f32 v[64:65], v[64:65], v[56:57], v[64:65]
    v_pk_fma_f32 v[68:69], v[68:69], v[58:59], v[68:69]
    v_pk_fma_f32 v[68:69], v[42:43], v[64:65], v[68:69]
    v_pk_fma_f32 v[64:65], v[64:65], v[58:59], v[64:65]
    v_pk_fma_f32 v[68:69], v[68:69], v[60:61], v[68:69]
    v_pk_fma_f32 v[68:69], v[44:45], v[64:65], v[68:69]
    v_pk_fma_f32 v[64:65], v[64:65], v[60:61], v[64:65]
    v_pk_fma_f32 v[68:69], v[68:69], v[62:63], v[68:69]
    v_pk_fma_f32 v[66:67], v[64:65], v[62:63], v[64:65]
    v_rcp_f32 v66, v66
    v_rcp_f32 v67, v67
    v_pk_fma_f32 v[68:69], v[46:47], v[64:65], v[68:69]
    v_pk_fma_f32 v[62:63], v[68:69], v[66:67], s[60:61]
    ds_add_u64 v96, v[62:63] offset:256
    s_cmp_eq_u32 s62, 5
    s_cbranch_scc1 K_P2O
    s_cmp_eq_u32 s62, 2
    s_cbranch_scc1 K_P1O
K_LDO:
    s_sub_u32 s62, s62, 1
    s_cmp_lg_u32 s62, s55
    s_cbranch_scc1 K_LOOPO
    s_cmp_lg_u32 s62, 0
    s_cbranch_scc1 K_TOQ
K_EPI:
    s_setprio 3
    v_xor_b32 v0, 32, v118
    s_lshl_b32 s3, s22, 5
    v_lshrrev_b32 v1, 4, v124
    v_lshl_add_u32 v1, v1, 3, s3
K_WUW:
    ds_read_b32 v4, v127 offset:296
    ds_read_b128 v[8:11], v123
    ds_read_b64 v[2:3], v1 offset:512
    s_waitcnt lgkmcnt(0)
    v_cmp_ne_u32 vcc, 16, v4
    s_cbranch_vccnz K_WUZ
    ds_read_b64_tr_b16 v[44:45], v118 offset:2048
    ds_read_b64_tr_b16 v[46:47], v118 offset:3072
    ds_read_b64_tr_b16 v[48:49], v0 offset:2048
    ds_read_b64_tr_b16 v[50:51], v0 offset:3072
    ds_read_b64_tr_b16 v[52:53], v118 offset:18432
    ds_read_b64_tr_b16 v[54:55], v118 offset:19456
    ds_read_b64_tr_b16 v[56:57], v0 offset:18432
    ds_read_b64_tr_b16 v[58:59], v0 offset:19456
    ds_read_b64_tr_b16 v[60:61], v118 offset:34816
    ds_read_b64_tr_b16 v[62:63], v118 offset:35840
    ds_read_b64_tr_b16 v[64:65], v0 offset:34816
    ds_read_b64_tr_b16 v[66:67], v0 offset:35840
    ds_read_b64_tr_b16 v[68:69], v118 offset:51200
    ds_read_b64_tr_b16 v[70:71], v118 offset:52224
    ds_read_b64_tr_b16 v[72:73], v0 offset:51200
    ds_read_b64_tr_b16 v[74:75], v0 offset:52224
    v_lshlrev_b32 v76, 16, v8
    v_and_b32 v77, 0xffff0000, v8
    v_lshlrev_b32 v78, 16, v9
    v_and_b32 v79, 0xffff0000, v9
    v_lshlrev_b32 v80, 16, v10
    v_and_b32 v81, 0xffff0000, v10
    v_lshlrev_b32 v82, 16, v11
    v_and_b32 v83, 0xffff0000, v11
    s_cmp_gt_u32 s22, 12
    s_barrier
    s_cbranch_scc1 K_NOCV
    ds_read_b128 v[16:19], v116
    ds_read_b128 v[20:23], v116 offset:16
    s_cmp_lg_u32 s69, 0
    s_waitcnt lgkmcnt(0)
    s_cbranch_scc1 K_NOCVT
    v_add_u32 v16, v16, v2
    v_add_u32 v17, v17, v3
    v_add_u32 v18, v18, v2
    v_add_u32 v19, v19, v3
    v_add_u32 v20, v20, v2
    v_add_u32 v21, v21, v3
    v_add_u32 v22, v22, v2
    v_add_u32 v23, v23, v3
    v_cvt_f32_i32 v16, v16
    v_cvt_f32_i32 v17, v17
    v_cvt_f32_i32 v18, v18
    v_cvt_f32_i32 v19, v19
    v_cvt_f32_i32 v20, v20
    v_cvt_f32_i32 v21, v21
    v_cvt_f32_i32 v22, v22
    v_cvt_f32_i32 v23, v23
    v_pk_mul_f32 v[16:17], v[16:17], s[64:65]
    v_pk_mul_f32 v[18:19], v[18:19], s[64:65]
    v_pk_mul_f32 v[20:21], v[20:21], s[64:65]
    v_pk_mul_f32 v[22:23], v[22:23], s[64:65]
K_NOCVT:
    v_cvt_pk_bf16_f32 v24, v16, v17
    v_cvt_pk_bf16_f32 v25, v18, v19
    v_cvt_pk_bf16_f32 v26, v20, v21
    v_cvt_pk_bf16_f32 v27, v22, v23
    ds_write_b128 v117, v[24:27] offset:512
K_NOCV:
    s_add_u32 s24, s16, s94
    s_addc_u32 s25, s17, 0
    s_mov_b32 s26, s95
    s_mov_b32 s27, 0x20000
    s_mov_b32 s66, 0xbfb8aa3b
    s_mov_b32 s67, 0xbfb8aa3b
    s_waitcnt lgkmcnt(0)
    s_barrier
    ds_read_b128 v[28:31], v119 offset:512
    ds_read_b128 v[32:35], v119 offset:576
    ds_read_b128 v[36:39], v119 offset:640
    ds_read_b128 v[40:43], v119 offset:704
    s_waitcnt lgkmcnt(3)
    v_mfma_f32_16x16x32_bf16 v[76:79], v[44:47], v[28:31], v[76:79]
    v_mfma_f32_16x16x32_bf16 v[80:83], v[48:51], v[28:31], v[80:83]
    s_waitcnt lgkmcnt(2)
    v_mfma_f32_16x16x32_bf16 v[76:79], v[52:55], v[32:35], v[76:79]
    v_mfma_f32_16x16x32_bf16 v[80:83], v[56:59], v[32:35], v[80:83]
    s_waitcnt lgkmcnt(1)
    v_mfma_f32_16x16x32_bf16 v[76:79], v[60:63], v[36:39], v[76:79]
    v_mfma_f32_16x16x32_bf16 v[80:83], v[64:67], v[36:39], v[80:83]
    s_waitcnt lgkmcnt(0)
    v_mfma_f32_16x16x32_bf16 v[76:79], v[68:71], v[40:43], v[76:79]
    v_mfma_f32_16x16x32_bf16 v[80:83], v[72:75], v[40:43], v[80:83]
    s_nop 6
    v_exp_f32 v16, v76
    v_exp_f32 v17, v77
    v_exp_f32 v18, v78
    v_exp_f32 v19, v79
    v_exp_f32 v20, v80
    v_exp_f32 v21, v81
    v_exp_f32 v22, v82
    v_exp_f32 v23, v83
    v_pk_fma_f32 v[16:17], v[16:17], s[66:67], s[66:67]
    v_pk_fma_f32 v[18:19], v[18:19], s[66:67], s[66:67]
    v_pk_fma_f32 v[20:21], v[20:21], s[66:67], s[66:67]
    v_pk_fma_f32 v[22:23], v[22:23], s[66:67], s[66:67]
    v_rcp_f32 v16, v16
    v_rcp_f32 v17, v17
    v_rcp_f32 v18, v18
    v_rcp_f32 v19, v19
    v_rcp_f32 v20, v20
    v_rcp_f32 v21, v21
    v_rcp_f32 v22, v22
    v_rcp_f32 v23, v23
    v_pk_mul_f32 v[16:17], v[16:17], v[76:77]
    v_pk_mul_f32 v[18:19], v[18:19], v[78:79]
    v_pk_mul_f32 v[20:21], v[20:21], v[80:81]
    v_pk_mul_f32 v[22:23], v[22:23], v[82:83]
    v_cvt_pk_bf16_f32 v24, v16, v17
    v_cvt_pk_bf16_f32 v25, v18, v19
    v_cvt_pk_bf16_f32 v26, v20, v21
    v_cvt_pk_bf16_f32 v27, v22, v23
    ds_write2_b64 v120, v[24:25], v[26:27] offset0:0 offset1:4
    ds_read_b128 v[16:19], v121
    s_waitcnt lgkmcnt(0)
    buffer_store_dwordx4 v[16:19], v122, s[24:27], 0 offen sc1
K_END:
    s_endpgm
K_TOQ:
    v_subrev_u32 v126, 252, v113
    ds_read_b32 v126, v126
    s_waitcnt lgkmcnt(0)
.p2align 3
K_LOOPQ:
    v_mfma_f32_32x32x16_bf16 v[32:47], v[8:11], v[84:87], 0
    v_exp_f32 v48, v16
    v_exp_f32 v49, v17
    v_exp_f32 v50, v18
    s_waitcnt lgkmcnt(2)
    v_lshl_add_u64 v[96:97], v[98:99], 0, v[110:111]
    v_add_u32 v109, v126, v110
    v_lshl_add_u64 v[100:101], v[100:101], 0, v[72:73]
    v_lshl_add_u64 v[102:103], v[102:103], 0, v[74:75]
    v_exp_f32 v51, v19
    v_exp_f32 v52, v20
    v_mfma_f32_32x32x16_bf16 v[32:47], v[12:15], v[88:91], v[32:47]
    v_exp_f32 v53, v21
    v_exp_f32 v54, v22
    v_exp_f32 v55, v23
    v_exp_f32 v56, v24
    v_exp_f32 v57, v25
    v_mfma_f32_32x32x16_bf16 v[32:47], v[92:95], v[80:83], v[32:47]
    v_exp_f32 v58, v26
    v_exp_f32 v59, v27
    v_exp_f32 v60, v28
    v_exp_f32 v61, v29
    v_exp_f32 v62, v30
    v_exp_f32 v63, v31
    v_pk_add_f32 v[64:65], v[48:49], 1.0 op_sel_hi:[1,0]
    v_pk_add_f32 v[66:67], v[56:57], 1.0 op_sel_hi:[1,0]
    v_pk_fma_f32 v[68:69], v[16:17], v[50:51], v[16:17]
    v_pk_fma_f32 v[70:71], v[24:25], v[58:59], v[24:25]
    v_pk_fma_f32 v[68:69], v[18:19], v[64:65], v[68:69]
    v_pk_fma_f32 v[70:71], v[26:27], v[66:67], v[70:71]
    v_pk_fma_f32 v[64:65], v[64:65], v[50:51], v[64:65]
    v_pk_fma_f32 v[66:67], v[66:67], v[58:59], v[66:67]
    v_pk_fma_f32 v[68:69], v[68:69], v[52:53], v[68:69]
    v_pk_fma_f32 v[70:71], v[70:71], v[60:61], v[70:71]
    v_pk_fma_f32 v[68:69], v[20:21], v[64:65], v[68:69]
    v_pk_fma_f32 v[70:71], v[28:29], v[66:67], v[70:71]
    v_pk_fma_f32 v[64:65], v[64:65], v[52:53], v[64:65]
    v_pk_fma_f32 v[66:67], v[66:67], v[60:61], v[66:67]
    v_pk_fma_f32 v[68:69], v[68:69], v[54:55], v[68:69]
    v_pk_fma_f32 v[70:71], v[70:71], v[62:63], v[70:71]
    v_pk_fma_f32 v[68:69], v[22:23], v[64:65], v[68:69]
    v_pk_fma_f32 v[70:71], v[30:31], v[66:67], v[70:71]
    v_pk_fma_f32 v[64:65], v[64:65], v[54:55], v[64:65]
    v_pk_fma_f32 v[66:67], v[66:67], v[62:63], v[66:67]
    v_rcp_f32 v64, v64
    v_rcp_f32 v65, v65
    s_waitcnt vmcnt(0)
    ds_read_b128 v[0:3], v104
    ds_read_b128 v[4:7], v105
    ds_read_b64_tr_b16 v[76:77], v97 offset:512
    s_mov_b64 exec, s[98:99]
    ds_read_b128 v[92:95], v115
    s_mov_b64 exec, -1
    ds_read_b128 v[8:11], v106
    ds_read_b128 v[12:15], v107
    ds_read_b64_tr_b16 v[80:81], v97 offset:640
    v_rcp_f32 v66, v66
    v_rcp_f32_e64 v67, v67
    v_pk_fma_f32 v[62:63], v[68:69], v[64:65], s[60:61]
    v_pk_fma_f32 v[60:61], v[70:71], v[66:67], s[60:61]
    ds_add_u64 v96, v[62:63] offset:0
    ds_add_u64 v109, v[60:61] offset:0
    s_waitcnt lgkmcnt(2)
    v_mfma_f32_32x32x16_bf16 v[16:31], v[0:3], v[84:87], 0
    v_exp_f32 v48, v32
    v_exp_f32 v49, v33
    v_exp_f32 v50, v34
    v_exp_f32 v51, v35
    v_exp_f32 v52, v36
    s_cmp_gt_u32 s62, 2
    s_cbranch_scc0 K_NODMAQ
    buffer_load_dwordx4 v100, s[32:35], s56 offen offset:0 sc1 lds
    buffer_load_dwordx4 v101, s[32:35], s57 offen offset:1024 sc1 lds
    buffer_load_dwordx4 v102, s[32:35], s58 offen offset:2048 sc1 lds
    buffer_load_dwordx4 v103, s[32:35], 0 offen offset:3072 sc1 lds
K_BACKQ:
    ds_read_b128 v[100:103], v112
    ds_read_b32 v99, v114
    ds_read_b32 v98, v113
    ds_read_b32 v126, v113 offset:4
    v_lshl_add_u64 v[112:113], v[112:113], 0, s[46:47]
    v_lshl_add_u64 v[114:115], v[114:115], 0, s[48:49]
    v_mfma_f32_32x32x16_bf16 v[16:31], v[4:7], v[88:91], v[16:31]
    v_exp_f32 v53, v37
    v_exp_f32 v54, v38
    v_exp_f32 v55, v39
    v_exp_f32 v56, v40
    v_exp_f32 v57, v41
    v_mfma_f32_32x32x16_bf16 v[16:31], v[92:95], v[76:79], v[16:31]
    v_exp_f32 v58, v42
    v_exp_f32 v59, v43
    v_exp_f32 v60, v44
    v_exp_f32 v61, v45
    v_exp_f32 v62, v46
    v_exp_f32_e64 v63, v47
    v_pk_add_f32 v[64:65], v[48:49], 1.0 op_sel_hi:[1,0]
    v_pk_add_f32 v[66:67], v[56:57], 1.0 op_sel_hi:[1,0]
    v_pk_fma_f32 v[68:69], v[32:33], v[50:51], v[32:33]
    v_pk_fma_f32 v[70:71], v[40:41], v[58:59], v[40:41]
    v_pk_fma_f32 v[68:69], v[34:35], v[64:65], v[68:69]
    v_pk_fma_f32 v[70:71], v[42:43], v[66:67], v[70:71]
    v_pk_fma_f32 v[64:65], v[64:65], v[50:51], v[64:65]
    v_pk_fma_f32 v[66:67], v[66:67], v[58:59], v[66:67]
    v_pk_fma_f32 v[68:69], v[68:69], v[52:53], v[68:69]
    v_pk_fma_f32 v[70:71], v[70:71], v[60:61], v[70:71]
    v_pk_fma_f32 v[68:69], v[36:37], v[64:65], v[68:69]
    v_pk_fma_f32 v[70:71], v[44:45], v[66:67], v[70:71]
    v_pk_fma_f32 v[64:65], v[64:65], v[52:53], v[64:65]
    v_pk_fma_f32 v[66:67], v[66:67], v[60:61], v[66:67]
    v_pk_fma_f32 v[68:69], v[68:69], v[54:55], v[68:69]
    v_pk_fma_f32 v[70:71], v[70:71], v[62:63], v[70:71]
    v_pk_fma_f32 v[68:69], v[38:39], v[64:65], v[68:69]
    v_pk_fma_f32 v[70:71], v[46:47], v[66:67], v[70:71]
    v_pk_fma_f32 v[64:65], v[64:65], v[54:55], v[64:65]
    v_pk_fma_f32 v[66:67], v[66:67], v[62:63], v[66:67]
    v_rcp_f32 v64, v64
    v_rcp_f32 v65, v65
    v_rcp_f32 v66, v66
    v_rcp_f32 v67, v67
    v_pk_fma_f32 v[62:63], v[68:69], v[64:65], s[60:61]
    v_pk_fma_f32 v[60:61], v[70:71], v[66:67], s[60:61]
    ds_add_u64 v96, v[62:63] offset:256
    ds_add_u64 v109, v[60:61] offset:256
    s_cmp_eq_u32 s62, 5
    s_cbranch_scc1 K_P2Q
    s_cmp_eq_u32 s62, 2
    s_cbranch_scc1 K_P1Q
K_LDQ:
    s_sub_u32 s62, s62, 1
    s_cmp_lg_u32 s62, 0
    s_cbranch_scc1 K_LOOPQ
    s_branch K_EPI
K_WUZ:
    s_sleep 2
    s_branch K_WUW
K_P2O:
    s_setprio 2
    s_branch K_LDO
K_P1O:
    s_setprio 1
    s_branch K_LDO
K_NODMAO:
    s_cmp_eq_u32 s62, 2
    s_cbranch_scc0 K_LASTITO
    s_lshr_b32 s3, s22, 3
    s_lshl_b32 s3, s3, 14
    s_lshl_b32 s44, s92, 8
    s_add_u32 s3, s3, s44
    s_add_u32 s3, s3, 32768
    s_add_u32 s45, s3, 7168
    s_and_b32 s44, s22, 1
    s_lshl_b32 s44, s44, 7
    v_and_b32 v100, 0x60, v111
    v_xor_b32 v100, s44, v100
    v_xor_b32 v100, v100, v108
    v_and_b32 v101, 0x300, v125
    v_lshl_add_u32 v100, v101, 3, v100
    buffer_load_dwordx4 v100, s[40:43], s3 offen lds
    buffer_load_dwordx4 v100, s[40:43], s45 offen offset:1024 lds
    s_branch K_BACKO
K_LASTITO:
    s_waitcnt vmcnt(0)
    v_mov_b32 v100, 1
    s_setprio 0
    s_mov_b64 exec, 1
    ds_add_u32 v127, v100 offset:296
    s_mov_b64 exec, -1
    s_branch K_BACKO
K_P2Q:
    s_setprio 2
    s_branch K_LDQ
K_P1Q:
    s_setprio 1
    s_branch K_LDQ
K_NODMAQ:
    s_cmp_eq_u32 s62, 2
    s_cbranch_scc0 K_LASTITQ
    s_lshr_b32 s3, s22, 3
    s_lshl_b32 s3, s3, 14
    s_lshl_b32 s44, s92, 8
    s_add_u32 s3, s3, s44
    s_add_u32 s3, s3, 32768
    s_add_u32 s45, s3, 7168
    s_and_b32 s44, s22, 1
    s_lshl_b32 s44, s44, 7
    v_and_b32 v100, 0x60, v111
    v_xor_b32 v100, s44, v100
    v_xor_b32 v100, v100, v108
    v_and_b32 v101, 0x300, v125
    v_lshl_add_u32 v100, v101, 3, v100
    buffer_load_dwordx4 v100, s[40:43], s3 offen lds
    buffer_load_dwordx4 v100, s[40:43], s45 offen offset:1024 lds
    s_branch K_BACKQ
K_LASTITQ:
    s_waitcnt vmcnt(0)
    v_mov_b32 v100, 1
    s_setprio 0
    s_mov_b64 exec, 1
    ds_add_u32 v127, v100 offset:296
    s_mov_b64 exec, -1
    s_branch K_BACKQ
K_FEW:
    s_lshr_b32 s3, s22, 3
    s_lshl_b32 s3, s3, 14
    s_lshl_b32 s44, s92, 8
    s_add_u32 s3, s3, s44
    s_add_u32 s3, s3, 32768
    s_add_u32 s45, s3, 7168
    s_and_b32 s44, s22, 1
    s_lshl_b32 s44, s44, 7
    v_and_b32 v64, 0x60, v111
    v_xor_b32 v64, s44, v64
    v_xor_b32 v64, v64, v108
    v_and_b32 v65, 0x300, v125
    v_lshl_add_u32 v64, v65, 3, v64
    buffer_load_dwordx4 v64, s[40:43], s3 offen lds
    buffer_load_dwordx4 v64, s[40:43], s45 offen offset:1024 lds
    s_cmp_eq_u32 s62, 1
    s_cbranch_scc1 K_PRE2
K_WUS:
    v_mov_b32 v100, 1
    s_waitcnt vmcnt(0)
    s_mov_b64 exec, 1
    ds_add_u32 v127, v100 offset:296
    s_mov_b64 exec, -1
    s_branch K_EPI
K_G:
    s_add_u32 s28, s20, 4096
    s_addc_u32 s29, s21, 0
    s_mov_b32 s30, s95
    s_mov_b32 s31, 0x20000
    s_add_u32 s28, s28, s94
    s_addc_u32 s29, s29, 0
    s_mov_b32 s90, 0xbfb8aa3b
    s_mov_b32 s91, 0xbfb8aa3b
    s_and_b32 s64, s92, 3
    s_lshr_b32 s65, s92, 2
    s_lshl_b32 s65, s65, 7
    s_lshl_b32 s66, s64, 12
    s_add_u32 s63, s66, s65
    v_and_b32 v108, 0xf0, v125
    v_and_b32 v4, 0x30, v124
    v_xor_b32 v4, v4, v108
    v_lshl_add_u32 v4, v108, 4, v4
    s_and_b32 s3, s22, 3
    s_lshl_b32 s3, s3, 12
    s_add_u32 s3, s3, 67584
    v_add_u32 v100, s3, v4
    v_and_b32 v4, 31, v124
    v_lshlrev_b32 v96, 3, v4
    v_and_b32 v4, 12, v124
    v_lshl_add_u32 v96, v4, 6, v96
    v_and_b32 v4, 0x30, v124
    v_lshl_add_u32 v96, v4, 7, v96
    v_xor_b32 v96, s65, v96
    v_xor_b32 v97, 32, v96
    v_xor_b32 v98, 64, v96
    v_xor_b32 v99, 96, v96
    v_xor_b32 v101, 64, v100
    v_xor_b32 v102, 128, v100
    v_xor_b32 v103, 192, v100
    v_lshrrev_b32 v5, 1, v108
    v_lshl_add_u32 v7, v4, 6, v5
    v_mov_b32 v24, v104
    v_mov_b32 v25, v105
    v_subrev_u32 v2, 512, v0
    v_add_u32 v0, s61, v125
    s_mov_b32 s93, 0x7fff7fff
    s_mul_i32 s67, s64, 13568
    s_add_u32 s67, s67, s65
    s_add_u32 s67, s67, 121216
    v_mul_u32_u24 v6, 212, v4
    v_add3_u32 v6, v6, v5, s67
    v_mul_u32_u24 v1, 12, v2
    v_add_u32 v1, 80448, v1
    v_mul_u32_u24 v3, 12, v124
    v_add_u32 v3, 98880, v3
    v_lshrrev_b32 v126, 2, v125
    s_lshl_b32 s3, s2, 7
    s_add_u32 s3, s3, 8060928
    v_and_b32 v27, 0x380, v125
    v_mul_u32_u24 v27, 255, v27
    v_add3_u32 v27, v27, v125, s3
    s_add_u32 s32, s20, 1024
    s_addc_u32 s33, s21, 0
    s_mov_b32 s34, 3203072
    s_mov_b32 s35, 0x20000
    s_add_u32 s36, s20, 3211264
    s_addc_u32 s37, s21, 0
    s_mov_b32 s38, 4832000
    s_mov_b32 s39, 0x20000
    s_mov_b32 s40, s14
    s_mov_b32 s41, s15
    s_mov_b32 s42, 65536
    s_mov_b32 s43, 0x20000
    s_lshl_b32 s3, s22, 6
    s_add_u32 s3, s3, 80384
    v_and_b32 v8, 0x30, v124
    v_add_u32 v112, s3, v8
    v_and_b32 v9, 3, v124
    v_lshlrev_b32 v111, 1, v8
    v_lshl_add_u32 v111, v9, 3, v111
    s_lshl_b32 s68, s22, 12
    s_add_u32 s68, s68, 2048
    s_lshl_b32 s3, s22, 4
    s_add_u32 s3, s3, 88064
    v_and_b32 v114, 12, v124
    v_lshl_add_u32 v109, v114, 6, v111
    v_add_u32 v114, s3, v114
    v_lshrrev_b32 v10, 5, v124
    v_lshl_add_u32 v113, v10, 3, s3
    v_lshrrev_b32 v110, 1, v125
    v_and_b32 v110, 0xf8, v110
    s_lshr_b32 s44, s22, 2
    s_and_b32 s45, s22, 3
    s_lshl_b32 s45, s45, 6
    s_mul_i32 s3, s44, 13568
    s_add_u32 s3, s3, 120704
    v_mul_u32_u24 v120, 53, v108
    v_add_u32 v120, s3, v120
    v_add_u32 v119, v120, v8
    v_lshrrev_b32 v11, 1, v8
    v_add3_u32 v120, v120, v11, s45
    s_add_u32 s3, s3, s45
    v_lshrrev_b32 v11, 2, v124
    v_mul_u32_u24 v121, 848, v11
    v_lshlrev_b32 v9, 4, v9
    v_add3_u32 v121, v121, v9, s3
    s_lshl_b32 s3, s44, 12
    s_add_u32 s3, s3, s45
    v_lshl_add_u32 v122, v11, 8, v9
    v_add_u32 v122, s3, v122
    s_mul_i32 s3, s22, 3392
    s_add_u32 s3, s3, 120704
    v_mul_u32_u24 v117, 53, v8
    v_add3_u32 v117, v117, v108, s3
    v_add_u32 v116, v117, v108
    v_and_b32 v9, 31, v124
    v_lshlrev_b32 v118, 3, v9
    v_and_b32 v9, 12, v124
    v_lshl_add_u32 v118, v9, 6, v118
    v_lshl_add_u32 v118, v8, 8, v118
    v_xor_b32 v118, s45, v118
    v_bfe_u32 v8, v124, 2, 1
    v_bfe_u32 v9, v124, 4, 1
    v_lshl_or_b32 v8, v8, 1, v9
    v_bfe_u32 v9, v124, 3, 1
    v_bfe_u32 v11, v124, 1, 1
    v_lshl_or_b32 v9, v9, 1, v11
    v_lshl_or_b32 v11, v8, 2, v9
    s_lshl_b32 s3, s22, 8
    s_add_u32 s3, s3, 89984
    v_lshl_add_u32 v115, v11, 4, s3
    v_lshl_or_b32 v8, v9, 2, v8
    v_and_b32 v9, 1, v124
    v_lshl_or_b32 v9, v9, 2, v10
    v_xor_b32 v9, v9, v11
    v_lshl_add_u32 v8, v8, 4, v9
    v_lshl_add_u32 v104, v8, 4, s68
    v_xor_b32 v105, 32, v104
    v_xor_b32 v106, 128, v104
    v_xor_b32 v107, 160, v104
    s_and_b32 s46, s22, 3
    s_lshr_b32 s44, s22, 2
    s_lshl_b32 s3, s44, 2
    s_add_u32 s3, s3, s46
    s_lshl_b32 s3, s3, 10
    s_lshl_b32 s45, s46, 6
    s_add_u32 s45, s45, 12288
    s_cmp_eq_u32 s44, 3
    s_cselect_b32 s3, s45, s3
    s_cselect_b32 s44, 4, 0
    s_add_u32 s3, s3, 67584
    v_lshrrev_b32 v8, s44, v125
    v_and_b32 v8, 0x3f0, v8
    v_add_u32 v123, s3, v8
    s_lshr_b32 s46, s65, 6
    s_mov_b32 s44, s64
    s_lshl_b32 s3, s44, 2
    s_add_u32 s3, s3, s46
    s_lshl_b32 s3, s3, 10
    s_lshl_b32 s45, s46, 6
    s_add_u32 s45, s45, 12288
    s_cmp_eq_u32 s44, 3
    s_cselect_b32 s3, s45, s3
    s_cselect_b32 s44, 4, 0
    s_add_u32 s3, s3, 67584
    v_lshrrev_b32 v8, s44, v125
    v_and_b32 v8, 0x3f0, v8
    v_add_u32 v5, s3, v8
    s_cmp_eq_u32 s64, 3
    s_cselect_b32 s50, 0xffff, -1
    s_cselect_b32 s51, 0, -1
    s_cselect_b32 s46, 64, 1024
    s_cselect_b32 s48, 0x10001, -1
    s_mov_b32 s49, s48
    v_add_u32 v4, s46, v5
    v_mov_b32 v2, v24
    s_setprio 2
    s_waitcnt vmcnt(0)
    s_mov_b64 exec, 1
    ds_add_u32 v127, v26 offset:264
    s_mov_b64 exec, -1
G_SY1:
    ds_read_b32 v24, v127 offset:264
    s_waitcnt lgkmcnt(0)
    v_cmp_ne_u32 vcc, 8, v24
    s_cbranch_vccnz G_SY1
    ds_read_b128 v[28:31], v100
    ds_read_b64_tr_b16 v[44:45], v96 offset:2048
    ds_read_b64_tr_b16 v[46:47], v96 offset:3072
    ds_read_b64_tr_b16 v[48:49], v97 offset:2048
    ds_read_b64_tr_b16 v[50:51], v97 offset:3072
    ds_read_b64_tr_b16 v[52:53], v98 offset:2048
    ds_read_b64_tr_b16 v[54:55], v98 offset:3072
    ds_read_b64_tr_b16 v[56:57], v99 offset:2048
    ds_read_b64_tr_b16 v[58:59], v99 offset:3072
    ds_read_b128 v[32:35], v101
    ds_read_b64_tr_b16 v[60:61], v96 offset:10240
    ds_read_b64_tr_b16 v[62:63], v96 offset:11264
    ds_read_b64_tr_b16 v[64:65], v97 offset:10240
    ds_read_b64_tr_b16 v[66:67], v97 offset:11264
    ds_read_b64_tr_b16 v[68:69], v98 offset:10240
    ds_read_b64_tr_b16 v[70:71], v98 offset:11264
    ds_read_b64_tr_b16 v[72:73], v99 offset:10240
    ds_read_b64_tr_b16 v[74:75], v99 offset:11264
    s_waitcnt lgkmcnt(9)
    v_mfma_f32_16x16x32_bf16 v[8:11], v[28:31], v[44:47], 0
    v_mfma_f32_16x16x32_bf16 v[12:15], v[28:31], v[48:51], 0
    v_mfma_f32_16x16x32_bf16 v[16:19], v[28:31], v[52:55], 0
    v_mfma_f32_16x16x32_bf16 v[20:23], v[28:31], v[56:59], 0
    ds_read_b128 v[36:39], v102
    ds_read_b64_tr_b16 v[44:45], v96 offset:18432
    ds_read_b64_tr_b16 v[46:47], v96 offset:19456
    ds_read_b64_tr_b16 v[48:49], v97 offset:18432
    ds_read_b64_tr_b16 v[50:51], v97 offset:19456
    ds_read_b64_tr_b16 v[52:53], v98 offset:18432
    ds_read_b64_tr_b16 v[54:55], v98 offset:19456
    ds_read_b64_tr_b16 v[56:57], v99 offset:18432
    ds_read_b64_tr_b16 v[58:59], v99 offset:19456
    s_waitcnt lgkmcnt(9)
    v_mfma_f32_16x16x32_bf16 v[8:11], v[32:35], v[60:63], v[8:11]
    v_mfma_f32_16x16x32_bf16 v[12:15], v[32:35], v[64:67], v[12:15]
    v_mfma_f32_16x16x32_bf16 v[16:19], v[32:35], v[68:71], v[16:19]
    v_mfma_f32_16x16x32_bf16 v[20:23], v[32:35], v[72:75], v[20:23]
    ds_read_b128 v[40:43], v103
    ds_read_b64_tr_b16 v[60:61], v96 offset:26624
    ds_read_b64_tr_b16 v[62:63], v96 offset:27648
    ds_read_b64_tr_b16 v[64:65], v97 offset:26624
    ds_read_b64_tr_b16 v[66:67], v97 offset:27648
    ds_read_b64_tr_b16 v[68:69], v98 offset:26624
    ds_read_b64_tr_b16 v[70:71], v98 offset:27648
    ds_read_b64_tr_b16 v[72:73], v99 offset:26624
    ds_read_b64_tr_b16 v[74:75], v99 offset:27648
    s_waitcnt lgkmcnt(9)
    v_mfma_f32_16x16x32_bf16 v[8:11], v[36:39], v[44:47], v[8:11]
    v_mfma_f32_16x16x32_bf16 v[12:15], v[36:39], v[48:51], v[12:15]
    v_mfma_f32_16x16x32_bf16 v[16:19], v[36:39], v[52:55], v[16:19]
    v_mfma_f32_16x16x32_bf16 v[20:23], v[36:39], v[56:59], v[20:23]
    s_waitcnt lgkmcnt(0)
    v_mfma_f32_16x16x32_bf16 v[8:11], v[40:43], v[60:63], v[8:11]
    v_mfma_f32_16x16x32_bf16 v[12:15], v[40:43], v[64:67], v[12:15]
    v_mfma_f32_16x16x32_bf16 v[16:19], v[40:43], v[68:71], v[16:19]
    v_mfma_f32_16x16x32_bf16 v[20:23], v[40:43], v[72:75], v[20:23]
    buffer_load_dwordx4 v[76:79], v2, s[24:27], s62 offen offset:0
    buffer_load_dwordx4 v[80:83], v2, s[24:27], s62 offen offset:1024
    buffer_load_dwordx4 v[84:87], v25, s[24:27], s62 offen offset:2048
    buffer_load_dwordx4 v[88:91], v25, s[24:27], s62 offen offset:3072
    s_nop 0
    v_pk_mul_f32 v[8:9], v[8:9], s[90:91]
    v_pk_mul_f32 v[10:11], v[10:11], s[90:91]
    v_pk_mul_f32 v[12:13], v[12:13], s[90:91]
    v_pk_mul_f32 v[14:15], v[14:15], s[90:91]
    v_pk_mul_f32 v[16:17], v[16:17], s[90:91]
    v_pk_mul_f32 v[18:19], v[18:19], s[90:91]
    v_pk_mul_f32 v[20:21], v[20:21], s[90:91]
    v_pk_mul_f32 v[22:23], v[22:23], s[90:91]
    v_cvt_pk_bf16_f32 v44, v8, v12
    v_cvt_pk_bf16_f32 v45, v16, v20
    buffer_store_dwordx2 v[44:45], v7, s[28:31], s63 offen offset:0 sc1
    v_cvt_pk_bf16_f32 v46, v9, v13
    v_cvt_pk_bf16_f32 v47, v17, v21
    buffer_store_dwordx2 v[46:47], v7, s[28:31], s63 offen offset:256 sc1
    v_cvt_pk_bf16_f32 v48, v10, v14
    v_cvt_pk_bf16_f32 v49, v18, v22
    buffer_store_dwordx2 v[48:49], v7, s[28:31], s63 offen offset:512 sc1
    v_cvt_pk_bf16_f32 v50, v11, v15
    v_cvt_pk_bf16_f32 v51, v19, v23
    buffer_store_dwordx2 v[50:51], v7, s[28:31], s63 offen offset:768 sc1
    v_add_u32 v8, 6144, v1
    v_add_u32 v9, 12288, v1
    s_cmp_eq_u32 s64, 3
    s_cbranch_scc0 G_NOZ
    v_mov_b32 v48, 0
    v_mov_b32 v49, 0
    v_mov_b32 v50, 0
    v_mov_b32 v51, 0
G_NOZ:
    v_and_b32 v24, s93, v44
    v_and_b32 v52, s93, v45
    v_pk_max_u16 v24, v24, v52
    v_and_b32 v52, s93, v46
    v_pk_max_u16 v24, v24, v52
    v_and_b32 v52, s93, v47
    v_pk_max_u16 v24, v24, v52
    v_and_b32 v52, s93, v48
    v_pk_max_u16 v24, v24, v52
    v_and_b32 v52, s93, v49
    v_pk_max_u16 v24, v24, v52
    v_and_b32 v52, s93, v50
    v_pk_max_u16 v24, v24, v52
    v_and_b32 v52, s93, v51
    v_pk_max_u16 v24, v24, v52
    v_lshlrev_b32 v52, 16, v24
    v_and_b32 v24, 0xffff0000, v24
    v_max_u32 v24, v24, v52
    s_mov_b64 exec, s[50:51]
    ds_max_u32 v126, v24 offset:512
    s_mov_b64 exec, -1
G_SY2:
    s_sleep 1
    ds_read_b32 v24, v127 offset:260
    s_waitcnt lgkmcnt(0)
    v_cmp_ne_u32 vcc, 7, v24
    s_cbranch_vccnz G_SY2
    s_cmpk_ge_u32 s2, 250
    s_cbranch_scc1 G_NOE
    ds_read2_b32 v[52:53], v1 offset0:0 offset1:1
    ds_read2_b32 v[54:55], v8 offset0:0 offset1:1
    ds_read2_b32 v[56:57], v9 offset0:0 offset1:1
    ds_read2_b32 v[58:59], v3 offset0:0 offset1:1
    s_waitcnt lgkmcnt(0)
    v_and_b32 v24, s93, v52
    v_and_b32 v60, s93, v53
    v_pk_max_u16 v24, v24, v60
    v_and_b32 v60, s93, v54
    v_pk_max_u16 v24, v24, v60
    v_and_b32 v60, s93, v55
    v_pk_max_u16 v24, v24, v60
    v_and_b32 v60, s93, v56
    v_pk_max_u16 v24, v24, v60
    v_and_b32 v60, s93, v57
    v_pk_max_u16 v24, v24, v60
    v_and_b32 v60, s93, v58
    v_pk_max_u16 v24, v24, v60
    v_and_b32 v60, s93, v59
    v_pk_max_u16 v24, v24, v60
    v_lshlrev_b32 v60, 16, v24
    v_and_b32 v24, 0xffff0000, v24
    v_max_u32 v24, v24, v60
    ds_max_u32 v126, v24 offset:768
G_NOE:
    s_waitcnt vmcnt(4)
    ds_write_b128 v0, v[76:79] offset:34816
    ds_write_b128 v0, v[80:83] offset:35840
    ds_write_b128 v0, v[84:87] offset:36864
    ds_write_b128 v0, v[88:91] offset:37888
    s_mov_b64 exec, 1
    ds_add_rtn_u32 v24, v127, v26 offset:268
    s_mov_b64 exec, -1
    s_waitcnt lgkmcnt(0)
    v_readfirstlane_b32 s3, v24
    s_cmp_eq_u32 s3, 7
    s_cbranch_scc1 G_CODE
G_CODED:
    v_add_u32 v58, 101696, v125
    s_waitcnt vmcnt(0)
    s_mov_b64 exec, 1
    ds_add_rtn_u32 v56, v127, v26 offset:288
    s_mov_b64 exec, -1
    ds_read_b128 v[52:55], v58
    ds_read_b32 v57, v127 offset:308
    s_waitcnt lgkmcnt(2)
    v_readfirstlane_b32 s3, v56
    s_cmp_lg_u32 s3, 15
    s_waitcnt lgkmcnt(0)
    s_cbranch_scc1 FIN27
    v_or_b32 v55, v55, v57
    global_store_dwordx4 v27, v[52:55], s[20:21] sc1
    s_mov_b64 exec, 1
    ds_add_u32 v127, v26 offset:288
    s_mov_b64 exec, -1
FIN27:
    s_setprio 0
G_SY3:
    ds_read_b32 v24, v127 offset:268
    s_waitcnt lgkmcnt(0)
    v_cmp_ne_u32 vcc, 8, v24
    s_cbranch_vccnz G_SY3
    ds_read_b64_tr_b16 v[44:45], v96 offset:34816
    ds_read_b64_tr_b16 v[46:47], v96 offset:35840
    ds_read_b64_tr_b16 v[48:49], v97 offset:34816
    ds_read_b64_tr_b16 v[50:51], v97 offset:35840
    ds_read_b64_tr_b16 v[52:53], v98 offset:34816
    ds_read_b64_tr_b16 v[54:55], v98 offset:35840
    ds_read_b64_tr_b16 v[56:57], v99 offset:34816
    ds_read_b64_tr_b16 v[58:59], v99 offset:35840
    ds_read_b64_tr_b16 v[60:61], v96 offset:43008
    ds_read_b64_tr_b16 v[62:63], v96 offset:44032
    ds_read_b64_tr_b16 v[64:65], v97 offset:43008
    ds_read_b64_tr_b16 v[66:67], v97 offset:44032
    ds_read_b64_tr_b16 v[68:69], v98 offset:43008
    ds_read_b64_tr_b16 v[70:71], v98 offset:44032
    ds_read_b64_tr_b16 v[72:73], v99 offset:43008
    ds_read_b64_tr_b16 v[74:75], v99 offset:44032
    s_waitcnt lgkmcnt(8)
    v_mfma_f32_16x16x32_bf16 v[8:11], v[28:31], v[44:47], 0
    v_mfma_f32_16x16x32_bf16 v[12:15], v[28:31], v[48:51], 0
    v_mfma_f32_16x16x32_bf16 v[16:19], v[28:31], v[52:55], 0
    v_mfma_f32_16x16x32_bf16 v[20:23], v[28:31], v[56:59], 0
    ds_read_b64_tr_b16 v[44:45], v96 offset:51200
    ds_read_b64_tr_b16 v[46:47], v96 offset:52224
    ds_read_b64_tr_b16 v[48:49], v97 offset:51200
    ds_read_b64_tr_b16 v[50:51], v97 offset:52224
    ds_read_b64_tr_b16 v[52:53], v98 offset:51200
    ds_read_b64_tr_b16 v[54:55], v98 offset:52224
    ds_read_b64_tr_b16 v[56:57], v99 offset:51200
    ds_read_b64_tr_b16 v[58:59], v99 offset:52224
    s_waitcnt lgkmcnt(8)
    v_mfma_f32_16x16x32_bf16 v[8:11], v[32:35], v[60:63], v[8:11]
    v_mfma_f32_16x16x32_bf16 v[12:15], v[32:35], v[64:67], v[12:15]
    v_mfma_f32_16x16x32_bf16 v[16:19], v[32:35], v[68:71], v[16:19]
    v_mfma_f32_16x16x32_bf16 v[20:23], v[32:35], v[72:75], v[20:23]
    ds_read_b64_tr_b16 v[60:61], v96 offset:59392
    ds_read_b64_tr_b16 v[62:63], v96 offset:60416
    ds_read_b64_tr_b16 v[64:65], v97 offset:59392
    ds_read_b64_tr_b16 v[66:67], v97 offset:60416
    ds_read_b64_tr_b16 v[68:69], v98 offset:59392
    ds_read_b64_tr_b16 v[70:71], v98 offset:60416
    ds_read_b64_tr_b16 v[72:73], v99 offset:59392
    ds_read_b64_tr_b16 v[74:75], v99 offset:60416
    s_waitcnt lgkmcnt(8)
    v_mfma_f32_16x16x32_bf16 v[8:11], v[36:39], v[44:47], v[8:11]
    v_mfma_f32_16x16x32_bf16 v[12:15], v[36:39], v[48:51], v[12:15]
    v_mfma_f32_16x16x32_bf16 v[16:19], v[36:39], v[52:55], v[16:19]
    v_mfma_f32_16x16x32_bf16 v[20:23], v[36:39], v[56:59], v[20:23]
    s_waitcnt lgkmcnt(0)
    v_mfma_f32_16x16x32_bf16 v[8:11], v[40:43], v[60:63], v[8:11]
    v_mfma_f32_16x16x32_bf16 v[12:15], v[40:43], v[64:67], v[12:15]
    v_mfma_f32_16x16x32_bf16 v[16:19], v[40:43], v[68:71], v[16:19]
    v_mfma_f32_16x16x32_bf16 v[20:23], v[40:43], v[72:75], v[20:23]
    s_nop 4
    v_pk_mul_f32 v[8:9], v[8:9], s[90:91]
    v_pk_mul_f32 v[10:11], v[10:11], s[90:91]
    v_pk_mul_f32 v[12:13], v[12:13], s[90:91]
    v_pk_mul_f32 v[14:15], v[14:15], s[90:91]
    v_pk_mul_f32 v[16:17], v[16:17], s[90:91]
    v_pk_mul_f32 v[18:19], v[18:19], s[90:91]
    v_pk_mul_f32 v[20:21], v[20:21], s[90:91]
    v_pk_mul_f32 v[22:23], v[22:23], s[90:91]
    v_cvt_pk_bf16_f32 v44, v8, v12
    v_cvt_pk_bf16_f32 v45, v16, v20
    v_cvt_pk_bf16_f32 v46, v9, v13
    v_cvt_pk_bf16_f32 v47, v17, v21
    v_cvt_pk_bf16_f32 v48, v10, v14
    v_cvt_pk_bf16_f32 v49, v18, v22
    v_cvt_pk_bf16_f32 v50, v11, v15
    v_cvt_pk_bf16_f32 v51, v19, v23
    v_mov_b32 v27, 0
    s_mov_b64 exec, s[50:51]
    ds_write_b64 v6, v[44:45] offset:0
    ds_write_b64 v6, v[46:47] offset:848
    ds_write_b64 v6, v[48:49] offset:1696
    ds_write_b64 v6, v[50:51] offset:2544
    s_cmp_eq_u32 s64, 3
    s_cbranch_scc0 G_NOZ2
    v_mov_b32 v48, 0
    v_mov_b32 v49, 0
    v_mov_b32 v50, 0
    v_mov_b32 v51, 0
G_NOZ2:
    v_and_b32 v27, s93, v44
    v_and_b32 v52, s93, v45
    v_pk_max_u16 v27, v27, v52
    v_and_b32 v52, s93, v46
    v_pk_max_u16 v27, v27, v52
    v_and_b32 v52, s93, v47
    v_pk_max_u16 v27, v27, v52
    v_and_b32 v52, s93, v48
    v_pk_max_u16 v27, v27, v52
    v_and_b32 v52, s93, v49
    v_pk_max_u16 v27, v27, v52
    v_and_b32 v52, s93, v50
    v_pk_max_u16 v27, v27, v52
    v_and_b32 v52, s93, v51
    v_pk_max_u16 v27, v27, v52
    v_lshlrev_b32 v52, 16, v27
    v_and_b32 v27, 0xffff0000, v27
    v_max_u32 v27, v27, v52
    s_mov_b64 exec, -1
    s_nop 0
    v_max_u32_dpp v27, v27, v27 row_shr:1 row_mask:0xf bank_mask:0xf
    s_nop 1
    v_max_u32_dpp v27, v27, v27 row_shr:2 row_mask:0xf bank_mask:0xf
    s_nop 1
    v_max_u32_dpp v27, v27, v27 row_shr:4 row_mask:0xf bank_mask:0xf
    s_nop 1
    v_max_u32_dpp v27, v27, v27 row_shr:8 row_mask:0xf bank_mask:0xf
    s_nop 1
    v_max_u32_dpp v27, v27, v27 row_bcast:15 row_mask:0xa bank_mask:0xf
    s_nop 1
    v_max_u32_dpp v27, v27, v27 row_bcast:31 row_mask:0xc bank_mask:0xf
    s_mov_b32 exec_lo, 0
    s_mov_b32 exec_hi, 0x80000000
    ds_max_u32 v127, v27 offset:276
    s_mov_b64 exec, -1
    s_cmp_eq_u32 s92, 7
    s_cbranch_scc1 G_WSUM
G_WSUMD:
    v_mov_b32 v84, 0
    v_mov_b32 v85, 0
    v_mov_b32 v86, 0
    v_mov_b32 v87, 0
    v_mov_b32 v88, 0
    v_mov_b32 v89, 0
    v_mov_b32 v90, 0
    v_mov_b32 v91, 0
    v_mov_b32 v92, 0
    v_mov_b32 v93, 0
    v_mov_b32 v94, 0
    v_mov_b32 v95, 0
    v_and_b32 v8, 0x30, v125
    s_movk_i32 s44, 0x3f80
    s_mov_b32 s45, 0
    s_mov_b32 exec_lo, 0xf
    s_mov_b32 exec_hi, 0xf00
    v_lshlrev_b64 v[84:85], v8, s[44:45]
    s_mov_b32 exec_lo, 0xf0
    s_mov_b32 exec_hi, 0xf000
    v_lshlrev_b64 v[86:87], v8, s[44:45]
    s_mov_b32 exec_lo, 0xf0000
    s_mov_b32 exec_hi, 0xf000000
    v_lshlrev_b64 v[88:89], v8, s[44:45]
    s_mov_b32 exec_lo, 0xf00000
    s_mov_b32 exec_hi, 0xf0000000
    v_lshlrev_b64 v[90:91], v8, s[44:45]
    s_mov_b64 exec, -1
    s_movk_i32 s56, 3072
    s_movk_i32 s57, 2048
    s_movk_i32 s58, 1024
    s_mov_b32 s98, 0x55555555
    s_mov_b32 s99, 0xaaaaaaaa
G_SY5:
    s_sleep 1
    ds_read_b32 v24, v127 offset:284
    s_waitcnt lgkmcnt(0)
    v_cmp_ne_u32 vcc, 8, v24
    s_cbranch_vccnz G_SY5
    ds_read_b64_tr_b16 v[44:45], v96 offset:2048
    ds_read_b64_tr_b16 v[46:47], v96 offset:3072
    ds_read_b64_tr_b16 v[48:49], v97 offset:2048
    ds_read_b64_tr_b16 v[50:51], v97 offset:3072
    ds_read_b64_tr_b16 v[52:53], v98 offset:2048
    ds_read_b64_tr_b16 v[54:55], v98 offset:3072
    ds_read_b64_tr_b16 v[56:57], v99 offset:2048
    ds_read_b64_tr_b16 v[58:59], v99 offset:3072
    ds_read_b64_tr_b16 v[60:61], v96 offset:10240
    ds_read_b64_tr_b16 v[62:63], v96 offset:11264
    ds_read_b64_tr_b16 v[64:65], v97 offset:10240
    ds_read_b64_tr_b16 v[66:67], v97 offset:11264
    ds_read_b64_tr_b16 v[68:69], v98 offset:10240
    ds_read_b64_tr_b16 v[70:71], v98 offset:11264
    ds_read_b64_tr_b16 v[72:73], v99 offset:10240
    ds_read_b64_tr_b16 v[74:75], v99 offset:11264
    s_waitcnt lgkmcnt(8)
    v_mfma_f32_16x16x32_bf16 v[8:11], v[44:47], v[28:31], 0
    v_mfma_f32_16x16x32_bf16 v[12:15], v[48:51], v[28:31], 0
    v_mfma_f32_16x16x32_bf16 v[16:19], v[52:55], v[28:31], 0
    v_mfma_f32_16x16x32_bf16 v[20:23], v[56:59], v[28:31], 0
    ds_read_b64_tr_b16 v[44:45], v96 offset:18432
    ds_read_b64_tr_b16 v[46:47], v96 offset:19456
    ds_read_b64_tr_b16 v[48:49], v97 offset:18432
    ds_read_b64_tr_b16 v[50:51], v97 offset:19456
    ds_read_b64_tr_b16 v[52:53], v98 offset:18432
    ds_read_b64_tr_b16 v[54:55], v98 offset:19456
    ds_read_b64_tr_b16 v[56:57], v99 offset:18432
    ds_read_b64_tr_b16 v[58:59], v99 offset:19456
    s_waitcnt lgkmcnt(8)
    v_mfma_f32_16x16x32_bf16 v[8:11], v[60:63], v[32:35], v[8:11]
    v_mfma_f32_16x16x32_bf16 v[12:15], v[64:67], v[32:35], v[12:15]
    v_mfma_f32_16x16x32_bf16 v[16:19], v[68:71], v[32:35], v[16:19]
    v_mfma_f32_16x16x32_bf16 v[20:23], v[72:75], v[32:35], v[20:23]
    ds_read_b64_tr_b16 v[60:61], v96 offset:26624
    ds_read_b64_tr_b16 v[62:63], v96 offset:27648
    ds_read_b64_tr_b16 v[64:65], v97 offset:26624
    ds_read_b64_tr_b16 v[66:67], v97 offset:27648
    ds_read_b64_tr_b16 v[68:69], v98 offset:26624
    ds_read_b64_tr_b16 v[70:71], v98 offset:27648
    ds_read_b64_tr_b16 v[72:73], v99 offset:26624
    ds_read_b64_tr_b16 v[74:75], v99 offset:27648
    s_waitcnt lgkmcnt(8)
    v_mfma_f32_16x16x32_bf16 v[8:11], v[44:47], v[36:39], v[8:11]
    v_mfma_f32_16x16x32_bf16 v[12:15], v[48:51], v[36:39], v[12:15]
    v_mfma_f32_16x16x32_bf16 v[16:19], v[52:55], v[36:39], v[16:19]
    v_mfma_f32_16x16x32_bf16 v[20:23], v[56:59], v[36:39], v[20:23]
    s_waitcnt lgkmcnt(0)
    v_mfma_f32_16x16x32_bf16 v[8:11], v[60:63], v[40:43], v[8:11]
    v_mfma_f32_16x16x32_bf16 v[12:15], v[64:67], v[40:43], v[12:15]
    v_mfma_f32_16x16x32_bf16 v[16:19], v[68:71], v[40:43], v[16:19]
    v_mfma_f32_16x16x32_bf16 v[20:23], v[72:75], v[40:43], v[20:23]
    v_and_b32 v72, 0x30, v124
    v_lshlrev_b32 v72, 2, v72
    v_xor_b32 v72, v72, v108
    v_xor_b32 v73, 16, v72
    v_xor_b32 v74, 32, v72
    v_xor_b32 v75, 48, v72
    v_pk_mul_f32 v[8:9], v[8:9], s[90:91]
    v_pk_mul_f32 v[10:11], v[10:11], s[90:91]
    v_pk_mul_f32 v[12:13], v[12:13], s[90:91]
    v_pk_mul_f32 v[14:15], v[14:15], s[90:91]
    v_pk_mul_f32 v[16:17], v[16:17], s[90:91]
    v_pk_mul_f32 v[18:19], v[18:19], s[90:91]
    v_pk_mul_f32 v[20:21], v[20:21], s[90:91]
    v_pk_mul_f32 v[22:23], v[22:23], s[90:91]
    v_cvt_pk_bf16_f32 v44, v8, v9
    v_cvt_pk_bf16_f32 v45, v10, v11
    v_cvt_pk_bf16_f32 v46, v12, v13
    v_cvt_pk_bf16_f32 v47, v14, v15
    v_cvt_pk_bf16_f32 v48, v16, v17
    v_cvt_pk_bf16_f32 v49, v18, v19
    v_cvt_pk_bf16_f32 v50, v20, v21
    v_cvt_pk_bf16_f32 v51, v22, v23
    s_mov_b64 exec, s[48:49]
    ds_write_b128 v5, v[44:47]
    ds_write_b128 v4, v[48:51]
    s_mov_b64 exec, -1
    v_mul_u32_u24 v22, 848, v124
    v_add_u32 v22, 120704, v22
    s_lshl_b32 s44, s92, 2
    s_add_u32 s44, s44, 83968
    s_setprio 1
    s_waitcnt lgkmcnt(0)
    s_barrier
    ds_read_b32 v16, v126 offset:0
    s_waitcnt lgkmcnt(0)
    v_add_u32 v17, 3, v16
    v_and_b32 v18, 4, v17
    v_and_b32 v20, -8, v17
    v_lshl_or_b32 v20, v18, 16, v20
    v_mov_b32 v19, v20
    v_cmp_ne_u32 vcc, 0, v18
    v_lshrrev_b32 v17, 2, v17
    v_add_u32_dpp v20, v20, v20 row_shr:1 row_mask:0xf bank_mask:0xf
    v_subrev_u32 v18, 4096, v18
    s_nop 0
    v_add_u32_dpp v20, v20, v20 row_shr:2 row_mask:0xf bank_mask:0xf
    s_nop 1
    v_add_u32_dpp v20, v20, v20 row_shr:4 row_mask:0xf bank_mask:0xf
    s_nop 1
    v_add_u32_dpp v20, v20, v20 row_shr:8 row_mask:0xf bank_mask:0xf
    s_nop 1
    v_add_u32_dpp v20, v20, v20 row_bcast:15 row_mask:0xa bank_mask:0xf
    s_nop 1
    v_add_u32_dpp v20, v20, v20 row_bcast:31 row_mask:0xc bank_mask:0xf
    s_nop 0
    v_readlane_b32 s63, v20, 63
    v_sub_u32 v20, v20, v19
    v_lshrrev_b32 v19, 16, v20
    v_and_b32 v20, 0xffff, v20
    s_add_u32 s54, s63, 8
    s_and_b32 s54, s54, 0xfff0
    s_add_u32 s3, s54, 4096
    v_sub_u32 v20, v20, v18
    v_add_u32 v19, s3, v19
    v_cndmask_b32 v19, v20, v19, vcc
    v_lshl_or_b32 v20, v20, 16, v19
    s_lshr_b32 s63, s63, 16
    s_add_u32 s63, s63, s54
    s_lshr_b32 s63, s63, 2
    v_subrev_u32 v24, s92, v17
    v_lshrrev_b32 v21, 16, v20
    v_add_u32 v23, s44, v21
    v_mov_b32 v25, v23
    s_mov_b32 m0, s68
    s_cmp_lg_u32 s92, 0
    s_cbranch_scc1 G_Q0
    v_add_u32 v25, s44, v19
G_Q0:
    s_cmpk_gt_u32 s63, 480
    s_cbranch_scc1 G_POSTD
G_POST:
    v_cmpx_lt_i32 vcc, 0, v24
    ds_write_b32 v25, v22
    v_cmpx_lt_i32 vcc, 8, v24
    ds_write_b32 v23, v22 offset:32
    v_cmpx_lt_i32 vcc, 16, v24
    v_add_u32 v23, 64, v23
    v_mov_b32 v25, v23
    v_subrev_u32 v24, 16, v24
    s_cbranch_execnz G_POST
    s_mov_b64 exec, -1
    s_cmp_ge_u32 s92, 3
    s_cbranch_scc1 G_POSTD
    v_add_u32 v23, s92, v16
    v_cmp_gt_u32 vcc, 4, v23
    v_lshlrev_b32 v24, 2, v17
    s_nop 0
    v_cndmask_b32 v21, v21, v19, vcc
    v_cmpx_lt_u32 vcc, v23, v24
    v_add_lshl_u32 v23, v23, v21, 4
    ds_write_b64 v23, v[92:93] offset:24448
    s_mov_b64 exec, -1
G_POSTD:
    s_barrier
    ds_read_b128 v[100:103], v112
    s_waitcnt lgkmcnt(0)
    v_lshl_add_u64 v[100:101], v[100:101], 0, v[72:73]
    v_lshl_add_u64 v[102:103], v[102:103], 0, v[74:75]
    s_barrier
    buffer_load_dwordx4 v100, s[32:35], s56 offen offset:0 sc1 lds
    buffer_load_dwordx4 v101, s[32:35], s57 offen offset:1024 sc1 lds
    buffer_load_dwordx4 v102, s[32:35], s58 offen offset:2048 sc1 lds
    buffer_load_dwordx4 v103, s[32:35], 0 offen offset:3072 sc1 lds
    s_branch K_POSTD
G_COR:
    s_cmp_lg_u32 s54, 0
    s_cselect_b32 s3, 1, 0
    v_add_u32 v17, s3, v17
    v_lshrrev_b32 v17, s3, v17
    v_mul_lo_u32 v34, v17, s60
    v_mul_hi_u32 v35, v17, s60
    v_lshlrev_b32 v23, 1, v126
    v_add_u32 v35, v35, v34
    v_sub_u32 v34, 0, v34
    v_sub_u32 v35, 0, v35
    ds_write_b64 v23, v[34:35] offset:512
    s_branch K_CORD
G_CODE:
    ds_read2st64_b32 v[24:25], v126 offset0:2 offset1:3
    s_waitcnt lgkmcnt(0)
    v_max_u32_dpp v24, v24, v24 row_shr:1 row_mask:0xf bank_mask:0xf
    v_max_u32_dpp v25, v25, v25 row_shr:1 row_mask:0xf bank_mask:0xf
    s_nop 0
    v_max_u32_dpp v24, v24, v24 row_shr:2 row_mask:0xf bank_mask:0xf
    v_max_u32_dpp v25, v25, v25 row_shr:2 row_mask:0xf bank_mask:0xf
    s_nop 0
    v_max_u32_dpp v24, v24, v24 row_shr:4 row_mask:0xf bank_mask:0xf
    v_max_u32_dpp v25, v25, v25 row_shr:4 row_mask:0xf bank_mask:0xf
    s_nop 0
    v_max_u32_dpp v24, v24, v24 row_shr:8 row_mask:0xf bank_mask:0xf
    v_max_u32_dpp v25, v25, v25 row_shr:8 row_mask:0xf bank_mask:0xf
    s_nop 0
    v_max_u32_dpp v24, v24, v24 row_bcast:15 row_mask:0xa bank_mask:0xf
    v_max_u32_dpp v25, v25, v25 row_bcast:15 row_mask:0xa bank_mask:0xf
    s_nop 0
    v_max_u32_dpp v24, v24, v24 row_bcast:31 row_mask:0xc bank_mask:0xf
    v_max_u32_dpp v25, v25, v25 row_bcast:31 row_mask:0xc bank_mask:0xf
    v_lshrrev_b32 v24, 20, v24
    v_lshrrev_b32 v25, 20, v25
    v_subrev_u32 v24, 855, v24
    v_subrev_u32 v25, 855, v25
    s_movk_i32 s3, 0xff
    v_med3_i32 v24, v24, 0, s3
    v_med3_i32 v25, v25, 0, s3
    v_lshlrev_b32 v25, 16, v25
    v_lshl_or_b32 v25, v24, 24, v25
    s_mov_b32 exec_lo, 0
    s_mov_b32 exec_hi, 0x80000000
    ds_write_b32 v127, v25 offset:308
    s_mov_b64 exec, -1
    s_branch G_CODED
G_WSUM:
    v_lshlrev_b32 v8, 16, v92
    v_and_b32 v12, 0xffff0000, v92
    v_lshlrev_b32 v9, 16, v93
    v_and_b32 v13, 0xffff0000, v93
    v_lshlrev_b32 v10, 16, v94
    v_and_b32 v14, 0xffff0000, v94
    v_lshlrev_b32 v11, 16, v95
    v_and_b32 v15, 0xffff0000, v95
    v_pk_mul_f32 v[8:9], v[8:9], s[90:91]
    v_cvt_pk_bf16_f32 v92, v8, v9
    v_pk_mul_f32 v[10:11], v[10:11], s[90:91]
    v_cvt_pk_bf16_f32 v93, v10, v11
    v_pk_mul_f32 v[12:13], v[12:13], s[90:91]
    v_cvt_pk_bf16_f32 v94, v12, v13
    v_pk_mul_f32 v[14:15], v[14:15], s[90:91]
    v_cvt_pk_bf16_f32 v95, v14, v15
    ds_write_b128 v125, v[92:95] offset:1024
    ds_read2st64_b32 v[12:13], v126 offset0:4 offset1:5
    ds_read2st64_b32 v[14:15], v126 offset0:6 offset1:7
    s_waitcnt lgkmcnt(0)
    v_lshlrev_b32 v44, 16, v12
    v_and_b32 v45, 0xffff0000, v12
    v_lshlrev_b32 v46, 16, v13
    v_and_b32 v47, 0xffff0000, v13
    v_lshlrev_b32 v48, 16, v14
    v_and_b32 v49, 0xffff0000, v14
    v_lshlrev_b32 v50, 16, v15
    v_and_b32 v51, 0xffff0000, v15
    v_add_f32 v16, |v44|, |v46|
    v_add_f32 v16, v16, |v48|
    v_add_f32 v16, v16, |v50|
    v_and_b32 v16, 0x7fffffff, v16
    v_add_f32 v17, |v45|, |v47|
    v_add_f32 v17, v17, |v49|
    v_add_f32 v17, v17, |v51|
    v_and_b32 v17, 0x7fffffff, v17
    v_max_u32 v16, v16, v17
    s_nop 1
    v_max_u32_dpp v16, v16, v16 row_shr:1 row_mask:0xf bank_mask:0xf
    s_nop 1
    v_max_u32_dpp v16, v16, v16 row_shr:2 row_mask:0xf bank_mask:0xf
    s_nop 1
    v_max_u32_dpp v16, v16, v16 row_shr:4 row_mask:0xf bank_mask:0xf
    s_nop 1
    v_max_u32_dpp v16, v16, v16 row_shr:8 row_mask:0xf bank_mask:0xf
    s_nop 1
    v_max_u32_dpp v16, v16, v16 row_bcast:15 row_mask:0xa bank_mask:0xf
    s_nop 1
    v_max_u32_dpp v16, v16, v16 row_bcast:31 row_mask:0xc bank_mask:0xf
    s_mov_b32 exec_lo, 0
    s_mov_b32 exec_hi, 0x80000000
    ds_write_b32 v127, v16 offset:272
    s_mov_b64 exec, -1
    s_branch G_WSUMD
R_WARM:
    s_lshr_b32 s3, s2, 3
    s_lshl_b32 s3, s3, 11
    s_mov_b64 exec, 0xffff
    v_lshlrev_b32 v8, 3, v125
    v_add_u32 v8, s3, v8
    global_load_dword v48, v8, s[14:15]
    global_load_dword v48, v8, s[12:13]
    s_mov_b64 exec, -1
    s_branch R_SY1
R_PUB:
    s_mul_i32 s59, s59, 1664525
    s_add_u32 s59, s59, 1013904223
    v_mov_b32 v24, s59
    v_lshl_or_b32 v25, v41, 16, v40
    v_lshl_or_b32 v26, v43, 16, v42
    v_add_u32 v27, v43, v39
    ds_write_b128 v49, v[24:27] offset:2048
    ds_write_b32 v127, v24 offset:304
    s_branch R_B3
R_RETRY:
    s_sub_u32 s3, s3, 1
    s_cmp_eq_u32 s3, 0
    s_cbranch_scc1 R_GIVEUP
    global_load_dwordx4 v[20:23], v52, s[20:21] sc1
    s_andn2_b64 exec, s[50:51], s[44:45]
    s_mov_b64 s[50:51], s[44:45]
    s_cbranch_execz R_NORP
    v_cndmask_b32 v24, v21, v22, s[46:47]
    v_cndmask_b32 v25, v22, v23, s[46:47]
    v_alignbit_b32 v24, v25, v24, s48
    v_lshrrev_b32 v25, 16, v24
    v_and_b32 v24, 0xffff, v24
    v_subrev_u32 v25, 1, v25
    v_max_u32 v25, v24, v25
    v_cndmask_b32 v24, v24, v25, vcc
    v_mad_u32_u24 v24, v24, 12, v53
    buffer_load_dword v71, v24, s[36:39], 0 offen offset:8 sc1
    s_mov_b64 exec, s[44:45]
    s_waitcnt vmcnt(1)
    s_branch R_POLL
R_NORP:
    s_mov_b64 exec, s[44:45]
    s_waitcnt vmcnt(0)
    s_branch R_POLL
R_GIVEUP:
    v_mov_b32 v21, 0
    v_mov_b32 v22, 0
    v_mov_b32 v23, 0
    s_branch R_POLLED
R_OVF:
    s_mov_b32 s63, 0
    v_mov_b32 v22, -1
    s_mov_b64 exec, 1
    ds_max_u32 v127, v22 offset:280
    s_branch R_EXPD
R_EXP:
    v_add_u32 v35, 12, v35
    ds_write_b32 v25, v35 offset:24
    v_add_u32 v25, 4, v25
    v_subrev_u32 v24, 1, v24
    v_cmpx_lt_u32 vcc, 6, v24
    s_cbranch_execnz R_EXP
    s_branch R_EXPD
K_SLOW:
    s_waitcnt vmcnt(0) lgkmcnt(0)
    s_lshr_b32 s3, s22, 3
    s_lshl_b32 s3, s3, 14
    s_lshl_b32 s44, s92, 8
    s_add_u32 s3, s3, s44
    s_add_u32 s3, s3, 32768
    s_add_u32 s45, s3, 7168
    s_and_b32 s44, s22, 1
    s_lshl_b32 s44, s44, 7
    v_and_b32 v64, 0x60, v111
    v_xor_b32 v64, s44, v64
    v_xor_b32 v64, v64, v108
    v_and_b32 v65, 0x300, v125
    v_lshl_add_u32 v64, v65, 3, v64
    buffer_load_dwordx4 v64, s[40:43], s3 offen lds
    buffer_load_dwordx4 v64, s[40:43], s45 offen offset:1024 lds
    v_lshrrev_b32 v23, 5, v124
    ds_read_b32 v36, v126 offset:1024
    ds_read_b32 v37, v126 offset:1280
    ds_read_b32 v38, v126 offset:1536
    ds_read_b32 v39, v126 offset:1792
    v_lshlrev_b32 v19, 8, v23
    v_add_u32 v19, v19, v108
    v_bfe_u32 v20, v124, 4, 1
    v_lshl_add_u32 v19, v20, 2, v19
    s_waitcnt lgkmcnt(0)
    s_cmp_ge_u32 s22, 8
    s_cbranch_scc1 K_WUS
    v_mov_b32 v100, 1
    s_waitcnt vmcnt(0)
    s_mov_b64 exec, 1
    ds_add_u32 v127, v100 offset:296
    s_mov_b64 exec, -1
    v_lshlrev_b32 v40, 16, v36
    v_and_b32 v41, 0xffff0000, v36
    v_lshlrev_b32 v42, 16, v37
    v_and_b32 v43, 0xffff0000, v37
    v_lshlrev_b32 v44, 16, v38
    v_and_b32 v45, 0xffff0000, v38
    v_lshlrev_b32 v46, 16, v39
    v_and_b32 v47, 0xffff0000, v39
    s_mov_b32 s48, 0
K_SCH:
    s_cmp_ge_u32 s48, 64
    s_cbranch_scc1 K_EPI
    v_readlane_b32 s49, v55, s48
    v_readlane_b32 s50, v56, s48
    s_add_u32 s48, s48, 2
K_SRE:
    s_cmp_eq_u32 s49, 0
    s_cbranch_scc1 K_SCH
    v_mov_b32 v20, s50
    buffer_load_dwordx3 v[28:30], v20, s[36:39], 0 offen sc1
    s_add_u32 s50, s50, 12
    s_sub_u32 s49, s49, 1
    s_waitcnt vmcnt(0)
    v_and_b32 v20, 0xffffff00, v30
    v_add_u32 v20, v20, v126
    buffer_load_dword v21, v20, s[32:35], s56 offen sc1
    v_bfe_u32 v22, v30, 2, 6
    v_mul_u32_u24 v22, 848, v22
    v_add_u32 v22, 120704, v22
    v_add_u32 v23, v22, v126
    v_add_u32 v22, v22, v19
    ds_read_b32 v23, v23 offset:512
    v_lshlrev_b32 v32, 16, v28
    v_and_b32 v33, 0xffff0000, v28
    v_lshlrev_b32 v34, 16, v29
    v_and_b32 v35, 0xffff0000, v29
    s_waitcnt vmcnt(0) lgkmcnt(0)
    v_lshlrev_b32 v24, 16, v21
    v_and_b32 v25, 0xffff0000, v21
    v_lshlrev_b32 v26, 16, v23
    v_and_b32 v27, 0xffff0000, v23
    v_add_f32 v24, v24, v26
    v_add_f32 v25, v25, v27
    v_fma_f32 v24, v32, v40, v24
    v_fma_f32 v25, v32, v41, v25
    v_fma_f32 v24, v33, v42, v24
    v_fma_f32 v25, v33, v43, v25
    v_fma_f32 v24, v34, v44, v24
    v_fma_f32 v25, v34, v45, v25
    v_fma_f32 v24, v35, v46, v24
    v_fma_f32 v25, v35, v47, v25
    v_exp_f32 v26, v24
    v_exp_f32 v27, v25
    v_add_f32 v26, 1.0, v26
    v_add_f32 v27, 1.0, v27
    v_rcp_f32 v26, v26
    v_rcp_f32 v27, v27
    v_mul_f32 v24, v24, v26
    v_mul_f32 v25, v25, v27
    ds_add_f32 v22, v24
    ds_add_f32 v22, v25 offset:8
K_LAST:
    s_branch K_SRE
.section .rodata,"a"
.p2align 6
.amdhsa_kernel standalone__mpnn_edge_mlp__graph_kernel
  .amdhsa_next_free_vgpr 128
  .amdhsa_next_free_sgpr 102
  .amdhsa_accum_offset 128
  .amdhsa_group_segment_fixed_size 0
  .amdhsa_kernarg_size 72
  .amdhsa_user_sgpr_count 2
  .amdhsa_user_sgpr_kernarg_segment_ptr 1
  .amdhsa_system_sgpr_workgroup_id_x 1
.end_amdhsa_kernel
```
